```python
import torch

def _softmax(x, axis=-1):
    return torch.softmax(x, dim=axis)
def _gelu(x):
    return torch.nn.functional.gelu(x, approximate="tanh")
def _silu(x):
    return torch.nn.functional.silu(x)
def _sigmoid(x):
    return torch.sigmoid(x)
def _layernorm(x, axis=-1, eps=1e-5):
    m = x.mean(dim=axis, keepdim=True)
    v = x.var(dim=axis, keepdim=True, unbiased=False)
    return (x - m) / torch.sqrt(v + eps)
def _scatter_add(tgt, idx, src, axis=0):
    return tgt.clone().index_add_(axis, idx, src)
def _segment_sum(src, seg, n):
    out = torch.zeros((n,) + src.shape[1:], dtype=src.dtype)
    return out.index_add_(0, seg, src)
def _pad(x, pw):
    flat = tuple(v for pair in reversed(pw) for v in pair)
    return torch.nn.functional.pad(x, flat)

kernel_name = 'concat_heads__sliding_block_cached__sliding_block_cached__decode'

def setup_inputs():

    _w = (lambda a: (lambda t: t.to(torch.bfloat16) if t.is_floating_point() else t)(torch.as_tensor(a)))
    def _A_setup():
        B, Sq, D = 2, 1, 576
        Hq, Hkv, Sk, Dh = 32, 16, 8192, 128
        assert Hq % Hkv == 0, (Hq, Hkv)
        return {
            "x": _w((lambda *s: torch.randn(*s, dtype=torch.bfloat16) * 0.8)(B, Sq, D)),
            "k_cache": _w((lambda *s: torch.randn(*s, dtype=torch.bfloat16) * 0.8)(B, Hkv, Sk, Dh)),
            "v_cache": _w((lambda *s: torch.randn(*s, dtype=torch.bfloat16) * 0.05)(B, Hkv, Sk, Dh)),
            "wq": _w((lambda *s: torch.randn(*s, dtype=torch.bfloat16) * 0.8)(D, Hq * Dh) * (D ** -0.5)),
            "wo": _w((lambda *s: torch.randn(*s, dtype=torch.bfloat16) * 0.05)(Hq * Dh, D) * ((Hq * Dh) ** -0.5)),
        }
    _A_in = _A_setup()

    def _B_setup():
        B, Sq, D = 2, 1, 576
        Hq, Hkv, Sk, Dh = 32, 16, 8192, 128
        assert Hq % Hkv == 0, (Hq, Hkv)
        return {
            "x": _w((lambda *s: torch.randn(*s, dtype=torch.bfloat16) * 0.8)(B, Sq, D)),
            "k_cache": _w((lambda *s: torch.randn(*s, dtype=torch.bfloat16) * 0.8)(B, Hkv, Sk, Dh)),
            "v_cache": _w((lambda *s: torch.randn(*s, dtype=torch.bfloat16) * 0.05)(B, Hkv, Sk, Dh)),
            "wq": _w((lambda *s: torch.randn(*s, dtype=torch.bfloat16) * 0.8)(D, Hq * Dh) * (D ** -0.5)),
            "wo": _w((lambda *s: torch.randn(*s, dtype=torch.bfloat16) * 0.05)(Hq * Dh, D) * ((Hq * Dh) ** -0.5)),
        }
    _B_in = _B_setup()

    return {
        "A_x": _A_in["x"],
        "A_k_cache": _A_in["k_cache"],
        "A_v_cache": _A_in["v_cache"],
        "A_wq": _A_in["wq"],
        "A_wo": _A_in["wo"],
        "B_x": _B_in["x"],
        "B_k_cache": _B_in["k_cache"],
        "B_v_cache": _B_in["v_cache"],
        "B_wq": _B_in["wq"],
        "B_wo": _B_in["wo"],
    }

def reference(A_x, A_k_cache, A_v_cache, A_wq, A_wo, B_x, B_k_cache, B_v_cache, B_wq, B_wo):
    def _A_ref(x, k_cache, v_cache, wq, wo):
        B, Sq, D = x.shape
        Hq, Dh = 32, 128
        Hkv, Sk = k_cache.shape[1], k_cache.shape[2]
        W = min(4096, max(256, Sk // 4))
        rep = Hq // Hkv
        q = (lambda x, *d: x.permute(*d))((x @ wq).reshape(B, Sq, Hq, Dh), 0, 2, 1, 3)
        k = (lambda x, n, axis: torch.repeat_interleave(x, n, dim=axis))(k_cache[:, :, Sk - W:, :], rep, axis=1)
        v = (lambda x, n, axis: torch.repeat_interleave(x, n, dim=axis))(v_cache[:, :, Sk - W:, :], rep, axis=1)
        scores = torch.einsum("bhqd,bhkd->bhqk", q, k) * (Dh ** -0.5)
        p = _softmax(scores, axis=-1)
        o = torch.einsum("bhqk,bhkd->bhqd", p, v)
        return (lambda x, *d: x.permute(*d))(o, 0, 2, 1, 3).reshape(B, Sq, Hq * Dh) @ wo

    def _B_ref(x, k_cache, v_cache, wq, wo):
        B, Sq, D = x.shape
        Hq, Dh = 32, 128
        Hkv, Sk = k_cache.shape[1], k_cache.shape[2]
        W = min(4096, max(256, Sk // 4))
        rep = Hq // Hkv
        q = (lambda x, *d: x.permute(*d))((x @ wq).reshape(B, Sq, Hq, Dh), 0, 2, 1, 3)
        k = (lambda x, n, axis: torch.repeat_interleave(x, n, dim=axis))(k_cache[:, :, Sk - W:, :], rep, axis=1)
        v = (lambda x, n, axis: torch.repeat_interleave(x, n, dim=axis))(v_cache[:, :, Sk - W:, :], rep, axis=1)
        scores = torch.einsum("bhqd,bhkd->bhqk", q, k) * (Dh ** -0.5)
        p = _softmax(scores, axis=-1)
        o = torch.einsum("bhqk,bhkd->bhqd", p, v)
        return (lambda x, *d: x.permute(*d))(o, 0, 2, 1, 3).reshape(B, Sq, Hq * Dh) @ wo

    a = _A_ref(A_x, A_k_cache, A_v_cache, A_wq, A_wo)
    b = _B_ref(B_x, B_k_cache, B_v_cache, B_wq, B_wo)
    return torch.concatenate([a, b], axis=-1)
```

```asm
; @launch grid=(256,1,1) block=(512,1,1) lds=143360
.amdgcn_target "amdgcn-amd-amdhsa--gfx950"
.text
.globl concat_heads__sliding_block_cached__sliding_block_cached__decode_kernel
.p2align 8
.type concat_heads__sliding_block_cached__sliding_block_cached__decode_kernel,@function
concat_heads__sliding_block_cached__sliding_block_cached__decode_kernel:
    s_cmp_ge_u32 s2, 256
    s_cbranch_scc1 L_exit
    s_load_dwordx16 s[16:31], s[0:1], 0
    s_load_dwordx8 s[32:39], s[0:1], 64
    s_load_dwordx2 s[40:41], s[0:1], 96
    v_lshrrev_b32 v6, 6, v0
    v_and_b32 v1, 63, v0
    v_mov_b32 v4, 0x20000
    v_readfirstlane_b32 s3, v6
    v_and_b32 v2, 15, v1
    v_lshrrev_b32 v3, 4, v1
    v_lshl_add_u32 v6, v1, 2, v4
    v_mov_b32 v7, 0
    s_cmp_lg_u32 s3, 0
    s_cbranch_scc1 L_nozero
    s_mov_b64 exec, 0xffff
    ds_write_b32 v6, v7
    s_mov_b64 exec, -1
L_nozero:
    s_and_b32 s10, s2, 7
    s_lshr_b32 s78, s2, 3
    s_lshr_b32 s11, s78, 3
    s_lshl_b32 s10, s10, 2
    s_add_u32 s4, s10, s11
    s_and_b32 s5, s78, 7
    s_lshr_b32 s6, s4, 4
    s_and_b32 s7, s4, 15
    s_lshr_b32 s8, s5, 2
    s_and_b32 s9, s5, 3
    s_lshl_b32 s76, s7, 3
    s_add_u32 s76, s76, s5
    s_and_b32 s14, s3, 3
    s_mov_b32 s66, 3014656
    s_mov_b32 s67, 0x20000
    s_cmp_ge_u32 s3, 4
    s_cbranch_scc1 L_swave
    s_mov_b32 s54, 4718592
    s_mov_b32 s55, 0x20000
    s_mov_b32 s62, 2304
    s_mov_b32 s63, 0x20000
    s_mov_b32 s58, 4718592
    s_mov_b32 s59, 0x20000
    s_mov_b32 s74, 4608
    s_mov_b32 s75, 0x20000
    v_lshlrev_b32 v14, 4, v1
    s_mul_i32 s13, s9, 144
    s_mul_i32 s11, s14, 36
    s_add_u32 s13, s13, s11
    s_lshl_b32 s12, s13, 13
    s_lshl_b32 s11, s7, 1
    s_add_u32 s11, s11, s8
    s_lshl_b32 s11, s11, 8
    s_add_u32 s12, s12, s11
    v_lshlrev_b32 v12, 13, v3
    v_lshl_add_u32 v12, v2, 4, v12
    v_bfe_u32 v13, v1, 3, 1
    v_mul_u32_u24 v13, 1152, v13
    v_lshl_add_u32 v13, v3, 1, v13
    s_lshl_b32 s13, s13, 1
    s_cmp_eq_u32 s6, 0
    s_waitcnt lgkmcnt(0)
    s_cselect_b32 s52, s22, s32
    s_cselect_b32 s53, s23, s33
    s_cselect_b32 s60, s16, s26
    s_cselect_b32 s61, s17, s27
    s_cselect_b32 s56, s24, s34
    s_cselect_b32 s57, s25, s35
    buffer_load_dwordx4 v[16:19], v12, s[52:55], s12 offen nt
    s_add_u32 s12, s12, 32768
    buffer_load_dwordx4 v[20:23], v12, s[52:55], s12 offen nt
    s_add_u32 s12, s12, 32768
    buffer_load_dwordx4 v[24:27], v12, s[52:55], s12 offen nt
    s_add_u32 s12, s12, 32768
    buffer_load_dwordx4 v[28:31], v12, s[52:55], s12 offen nt
    s_add_u32 s12, s12, 32768
    buffer_load_dwordx4 v[32:35], v12, s[52:55], s12 offen nt
    s_add_u32 s12, s12, 32768
    buffer_load_dwordx4 v[36:39], v12, s[52:55], s12 offen nt
    s_add_u32 s12, s12, 32768
    buffer_load_dwordx4 v[40:43], v12, s[52:55], s12 offen nt
    s_add_u32 s12, s12, 32768
    buffer_load_dwordx4 v[44:47], v12, s[52:55], s12 offen nt
    s_add_u32 s12, s12, 32768
    buffer_load_dwordx4 v[48:51], v12, s[52:55], s12 offen nt
    buffer_load_ushort v52, v13, s[60:63], s13 offen offset:0
    buffer_load_ushort v53, v13, s[60:63], s13 offen offset:8
    buffer_load_ushort v54, v13, s[60:63], s13 offen offset:16
    buffer_load_ushort v55, v13, s[60:63], s13 offen offset:24
    buffer_load_ushort v56, v13, s[60:63], s13 offen offset:32
    buffer_load_ushort v57, v13, s[60:63], s13 offen offset:40
    buffer_load_ushort v58, v13, s[60:63], s13 offen offset:48
    buffer_load_ushort v59, v13, s[60:63], s13 offen offset:56
    buffer_load_ushort v60, v13, s[60:63], s13 offen offset:64
    s_mov_b32 s64, s40
    s_mov_b32 s65, s41
    s_mov_b32 s72, s36
    s_mov_b32 s73, s37
    s_lshl_b32 s10, s6, 8
    s_add_u32 s10, s10, 589824
    s_load_dword s79, s[40:41], s10
    s_barrier
    v_and_b32 v6, 1, v1
    v_lshlrev_b32 v6, 4, v6
    v_mov_b32 v7, 0xffff
    v_lshlrev_b32 v7, v6, v7
    v_bfe_u32 v6, v1, 1, 2
    v_cmp_eq_u32 vcc, 0, v6
    s_nop 1
    v_cndmask_b32 v8, 0, v7, vcc
    v_cmp_eq_u32 vcc, 1, v6
    s_nop 1
    v_cndmask_b32 v9, 0, v7, vcc
    v_cmp_eq_u32 vcc, 2, v6
    s_nop 1
    v_cndmask_b32 v10, 0, v7, vcc
    v_cmp_eq_u32 vcc, 3, v6
    s_nop 1
    v_cndmask_b32 v11, 0, v7, vcc
    v_mov_b32 v62, 0xfffffc00
    s_waitcnt lgkmcnt(0)
    s_add_u32 s79, s79, 1
    s_and_b32 s79, s79, 0x3ff
    s_waitcnt vmcnt(0)
    v_lshl_or_b32 v6, v52, 16, v52
    v_and_b32 v64, v8, v6
    v_and_b32 v65, v9, v6
    v_and_b32 v66, v10, v6
    v_and_b32 v67, v11, v6
    s_nop 1
    v_mfma_f32_16x16x32_bf16 v[72:75], v[64:67], v[16:19], 0
    v_lshl_or_b32 v6, v53, 16, v53
    v_and_b32 v68, v8, v6
    v_and_b32 v69, v9, v6
    v_and_b32 v70, v10, v6
    v_and_b32 v71, v11, v6
    s_nop 1
    v_mfma_f32_16x16x32_bf16 v[72:75], v[68:71], v[20:23], v[72:75]
    v_lshl_or_b32 v6, v54, 16, v54
    v_and_b32 v64, v8, v6
    v_and_b32 v65, v9, v6
    v_and_b32 v66, v10, v6
    v_and_b32 v67, v11, v6
    s_nop 1
    v_mfma_f32_16x16x32_bf16 v[72:75], v[64:67], v[24:27], v[72:75]
    v_lshl_or_b32 v6, v55, 16, v55
    v_and_b32 v68, v8, v6
    v_and_b32 v69, v9, v6
    v_and_b32 v70, v10, v6
    v_and_b32 v71, v11, v6
    s_nop 1
    v_mfma_f32_16x16x32_bf16 v[72:75], v[68:71], v[28:31], v[72:75]
    v_lshl_or_b32 v6, v56, 16, v56
    v_and_b32 v64, v8, v6
    v_and_b32 v65, v9, v6
    v_and_b32 v66, v10, v6
    v_and_b32 v67, v11, v6
    s_nop 1
    v_mfma_f32_16x16x32_bf16 v[72:75], v[64:67], v[32:35], v[72:75]
    v_lshl_or_b32 v6, v57, 16, v57
    v_and_b32 v68, v8, v6
    v_and_b32 v69, v9, v6
    v_and_b32 v70, v10, v6
    v_and_b32 v71, v11, v6
    s_nop 1
    v_mfma_f32_16x16x32_bf16 v[72:75], v[68:71], v[36:39], v[72:75]
    v_lshl_or_b32 v6, v58, 16, v58
    v_and_b32 v64, v8, v6
    v_and_b32 v65, v9, v6
    v_and_b32 v66, v10, v6
    v_and_b32 v67, v11, v6
    s_nop 1
    v_mfma_f32_16x16x32_bf16 v[72:75], v[64:67], v[40:43], v[72:75]
    v_lshl_or_b32 v6, v59, 16, v59
    v_and_b32 v68, v8, v6
    v_and_b32 v69, v9, v6
    v_and_b32 v70, v10, v6
    v_and_b32 v71, v11, v6
    s_nop 1
    v_mfma_f32_16x16x32_bf16 v[72:75], v[68:71], v[44:47], v[72:75]
    v_lshl_or_b32 v6, v60, 16, v60
    v_and_b32 v64, v8, v6
    v_and_b32 v65, v9, v6
    v_and_b32 v66, v10, v6
    v_and_b32 v67, v11, v6
    s_nop 1
    v_mfma_f32_16x16x32_bf16 v[72:75], v[64:67], v[48:51], v[72:75]
    s_nop 7
    s_lshl_b32 s10, s14, 10
    v_add_u32 v15, s10, v14
    v_add_u32 v15, 135168, v15
    ds_write_b128 v15, v[72:75]
    s_waitcnt lgkmcnt(0)
    s_mov_b64 exec, 1
    v_mov_b32 v6, 1
    ds_add_u32 v4, v6 offset:0
    s_mov_b64 exec, -1
    s_cmp_lg_u32 s14, 3
    s_cbranch_scc1 L_cw_1
    s_cmp_lg_u32 s5, 0
    s_cbranch_scc1 L_cw_1
    s_getpc_b64 s[26:27]
L_here:
    s_add_u32 s26, s26, L_cjoin-L_here
    s_addc_u32 s27, s27, 0
    global_load_dwordx4 v[144:147], v14, s[26:27]
    s_add_u32 s26, s26, 1024
    s_addc_u32 s27, s27, 0
    global_load_dwordx4 v[148:151], v14, s[26:27]
    s_add_u32 s26, s26, 1024
    s_addc_u32 s27, s27, 0
    global_load_dwordx4 v[152:155], v14, s[26:27]
    s_add_u32 s26, s26, 1024
    s_addc_u32 s27, s27, 0
    global_load_dwordx4 v[156:159], v14, s[26:27]
    s_add_u32 s26, s26, 1024
    s_addc_u32 s27, s27, 0
    global_load_dwordx4 v[160:163], v14, s[26:27]
    s_add_u32 s26, s26, 1024
    s_addc_u32 s27, s27, 0
    global_load_dwordx4 v[164:167], v14, s[26:27]
    s_add_u32 s26, s26, 1024
    s_addc_u32 s27, s27, 0
    global_load_dwordx4 v[168:171], v14, s[26:27]
    s_getpc_b64 s[26:27]
L_here2:
    s_add_u32 s26, s26, L_exit-L_here2-1020
    s_addc_u32 s27, s27, 0
    global_load_dwordx4 v[172:175], v14, s[26:27]
L_cw_1:
    s_cmp_lg_u32 s14, 0
    s_cbranch_scc1 L_cjoin
    s_mov_b32 s15, 400000
L_spin_2:
    ds_read_b32 v6, v4 offset:0
    s_waitcnt lgkmcnt(0)
    v_readfirstlane_b32 s10, v6
    s_nop 0
    s_cmp_ge_u32 s10, 4
    s_cbranch_scc1 L_done_3
    s_sub_u32 s15, s15, 1
    s_cbranch_scc0 L_spin_2
L_done_3:
    v_add_u32 v15, 135168, v14
    ds_read_b128 v[16:19], v15 offset:0
    ds_read_b128 v[20:23], v15 offset:1024
    ds_read_b128 v[24:27], v15 offset:2048
    ds_read_b128 v[28:31], v15 offset:3072
    v_lshrrev_b32 v34, 1, v3
    v_lshlrev_b32 v34, 9, v34
    v_lshl_add_u32 v34, v2, 5, v34
    v_and_b32 v7, 1, v3
    v_lshl_add_u32 v34, v7, 4, v34
    s_lshl_b32 s13, s4, 3
    s_add_u32 s13, s13, s5
    s_lshl_b32 s16, s13, 10
    s_getreg_b32 s18, hwreg(HW_REG_XCC_ID, 0, 4)
    s_lshl_b32 s18, s18, 10
    s_or_b32 s13, s18, s79
    v_mov_b32 v40, s13
    v_mov_b32 v41, s13
    v_mov_b32 v42, s13
    v_mov_b32 v43, s13
    s_lshl_b32 s19, s4, 10
    s_add_u32 s20, s19, 622592
    s_lshl_b32 s19, s5, 7
    s_add_u32 s19, s19, s20
    v_mov_b32 v33, 0
    s_waitcnt lgkmcnt(0)
    v_add_f32 v16, v16, v20
    v_add_f32 v24, v24, v28
    v_add_f32 v17, v17, v21
    v_add_f32 v25, v25, v29
    v_add_f32 v18, v18, v22
    v_add_f32 v26, v26, v30
    v_add_f32 v19, v19, v23
    v_add_f32 v27, v27, v31
    v_add_f32 v36, v16, v24
    v_add_f32 v37, v17, v25
    v_add_f32 v38, v18, v26
    v_add_f32 v39, v19, v27
    v_add_u32 v36, 0x200, v36
    v_add_u32 v37, 0x200, v37
    v_add_u32 v38, 0x200, v38
    v_add_u32 v39, 0x200, v39
    v_and_or_b32 v36, v36, v62, s79
    v_and_or_b32 v37, v37, v62, s79
    v_and_or_b32 v38, v38, v62, s79
    v_and_or_b32 v39, v39, v62, s79
    buffer_store_dwordx4 v[36:39], v34, s[64:67], s16 offen
    s_mov_b64 exec, 1
    buffer_store_dwordx4 v[40:43], v33, s[64:67], s19 offen
    s_mov_b64 exec, -1
    v_lshrrev_b32 v6, 5, v1
    v_lshlrev_b32 v6, 12, v6
    v_and_b32 v7, 31, v1
    v_lshl_add_u32 v6, v7, 4, v6
    s_lshl_b32 s12, s4, 13
    s_lshl_b32 s13, s8, 9
    s_add_u32 s12, s12, s13
    v_lshrrev_b32 v15, 5, v1
    v_lshlrev_b32 v15, 8, v15
    v_lshl_add_u32 v15, v7, 3, v15
    v_add_u32 v15, 131328, v15
    v_and_b32 v35, 7, v1
    v_lshlrev_b32 v35, 7, v35
    s_mov_b32 s17, 0
    s_mov_b32 s15, 20
L_qa_4:
    buffer_load_dwordx4 v[16:19], v6, s[64:67], s12 offen offset:0 nt
    buffer_load_dwordx4 v[20:23], v6, s[64:67], s12 offen offset:1024 nt
    buffer_load_dwordx4 v[24:27], v6, s[64:67], s12 offen offset:2048 nt
    buffer_load_dwordx4 v[28:31], v6, s[64:67], s12 offen offset:3072 nt
    buffer_load_dwordx4 v[52:55], v35, s[64:67], s20 offen nt
    s_waitcnt vmcnt(0)
    v_xor_b32 v16, s79, v16
    v_xor_b32 v17, s79, v17
    v_xor_b32 v18, s79, v18
    v_xor_b32 v19, s79, v19
    v_xor_b32 v20, s79, v20
    v_xor_b32 v21, s79, v21
    v_xor_b32 v22, s79, v22
    v_xor_b32 v23, s79, v23
    v_xor_b32 v24, s79, v24
    v_xor_b32 v25, s79, v25
    v_xor_b32 v26, s79, v26
    v_xor_b32 v27, s79, v27
    v_xor_b32 v28, s79, v28
    v_xor_b32 v29, s79, v29
    v_xor_b32 v30, s79, v30
    v_xor_b32 v31, s79, v31
    v_xor_b32 v52, s79, v52
    v_xor_b32 v53, s79, v53
    v_xor_b32 v54, s79, v54
    v_xor_b32 v55, s79, v55
    v_or3_b32 v64, v16, v17, v18
    v_or3_b32 v65, v19, v20, v21
    v_or3_b32 v66, v22, v23, v24
    v_or3_b32 v67, v25, v26, v27
    v_or3_b32 v68, v28, v29, v30
    v_or3_b32 v69, v31, v52, v53
    v_or_b32 v70, v54, v55
    v_or3_b32 v71, v64, v65, v66
    v_or3_b32 v72, v67, v68, v69
    v_or3_b32 v73, v71, v72, v70
    v_and_b32 v74, 0x3ff, v73
    v_cmp_ne_u32 vcc, 0, v74
    s_nop 1
    s_cmp_eq_u64 vcc, 0
    s_cbranch_scc1 L_qd_6
    s_sub_u32 s15, s15, 1
    s_cbranch_scc0 L_qa_4
    s_add_u32 s16, s16, 2359296
    s_add_u32 s19, s19, 2359296
    buffer_store_dwordx4 v[36:39], v34, s[64:67], s16 offen sc1
    s_mov_b64 exec, 1
    buffer_store_dwordx4 v[40:43], v33, s[64:67], s19 offen sc1
    s_mov_b64 exec, -1
    s_mov_b32 s17, 1
    s_add_u32 s21, s12, 2359296
    s_add_u32 s22, s20, 2359296
    s_mov_b32 s15, 40000
L_qb_5:
    buffer_load_dwordx4 v[16:19], v6, s[64:67], s21 offen offset:0 sc1
    buffer_load_dwordx4 v[20:23], v6, s[64:67], s21 offen offset:1024 sc1
    buffer_load_dwordx4 v[24:27], v6, s[64:67], s21 offen offset:2048 sc1
    buffer_load_dwordx4 v[28:31], v6, s[64:67], s21 offen offset:3072 sc1
    buffer_load_dwordx4 v[52:55], v35, s[64:67], s22 offen sc1
    s_waitcnt vmcnt(0)
    v_xor_b32 v16, s79, v16
    v_xor_b32 v17, s79, v17
    v_xor_b32 v18, s79, v18
    v_xor_b32 v19, s79, v19
    v_xor_b32 v20, s79, v20
    v_xor_b32 v21, s79, v21
    v_xor_b32 v22, s79, v22
    v_xor_b32 v23, s79, v23
    v_xor_b32 v24, s79, v24
    v_xor_b32 v25, s79, v25
    v_xor_b32 v26, s79, v26
    v_xor_b32 v27, s79, v27
    v_xor_b32 v28, s79, v28
    v_xor_b32 v29, s79, v29
    v_xor_b32 v30, s79, v30
    v_xor_b32 v31, s79, v31
    v_xor_b32 v52, s79, v52
    v_xor_b32 v53, s79, v53
    v_xor_b32 v54, s79, v54
    v_xor_b32 v55, s79, v55
    v_or3_b32 v64, v16, v17, v18
    v_or3_b32 v65, v19, v20, v21
    v_or3_b32 v66, v22, v23, v24
    v_or3_b32 v67, v25, v26, v27
    v_or3_b32 v68, v28, v29, v30
    v_or3_b32 v69, v31, v52, v53
    v_or_b32 v70, v54, v55
    v_or3_b32 v71, v64, v65, v66
    v_or3_b32 v72, v67, v68, v69
    v_or3_b32 v73, v71, v72, v70
    v_and_b32 v74, 0x3ff, v73
    v_cmp_ne_u32 vcc, 0, v74
    s_nop 1
    s_cmp_eq_u64 vcc, 0
    s_cbranch_scc1 L_qd_6
    buffer_load_dwordx4 v[16:19], v6, s[64:67], s12 offen offset:0 nt
    buffer_load_dwordx4 v[20:23], v6, s[64:67], s12 offen offset:1024 nt
    buffer_load_dwordx4 v[24:27], v6, s[64:67], s12 offen offset:2048 nt
    buffer_load_dwordx4 v[28:31], v6, s[64:67], s12 offen offset:3072 nt
    buffer_load_dwordx4 v[52:55], v35, s[64:67], s20 offen nt
    s_waitcnt vmcnt(0)
    v_xor_b32 v16, s79, v16
    v_xor_b32 v17, s79, v17
    v_xor_b32 v18, s79, v18
    v_xor_b32 v19, s79, v19
    v_xor_b32 v20, s79, v20
    v_xor_b32 v21, s79, v21
    v_xor_b32 v22, s79, v22
    v_xor_b32 v23, s79, v23
    v_xor_b32 v24, s79, v24
    v_xor_b32 v25, s79, v25
    v_xor_b32 v26, s79, v26
    v_xor_b32 v27, s79, v27
    v_xor_b32 v28, s79, v28
    v_xor_b32 v29, s79, v29
    v_xor_b32 v30, s79, v30
    v_xor_b32 v31, s79, v31
    v_xor_b32 v52, s79, v52
    v_xor_b32 v53, s79, v53
    v_xor_b32 v54, s79, v54
    v_xor_b32 v55, s79, v55
    v_or3_b32 v64, v16, v17, v18
    v_or3_b32 v65, v19, v20, v21
    v_or3_b32 v66, v22, v23, v24
    v_or3_b32 v67, v25, v26, v27
    v_or3_b32 v68, v28, v29, v30
    v_or3_b32 v69, v31, v52, v53
    v_or_b32 v70, v54, v55
    v_or3_b32 v71, v64, v65, v66
    v_or3_b32 v72, v67, v68, v69
    v_or3_b32 v73, v71, v72, v70
    v_and_b32 v74, 0x3ff, v73
    v_cmp_ne_u32 vcc, 0, v74
    s_nop 1
    s_cmp_eq_u64 vcc, 0
    s_cbranch_scc1 L_qd_6
    s_sub_u32 s15, s15, 1
    s_cbranch_scc0 L_qb_5
L_qd_6:
    v_add_f32 v16, v16, v20
    v_add_f32 v24, v24, v28
    v_add_f32 v17, v17, v21
    v_add_f32 v25, v25, v29
    v_add_f32 v18, v18, v22
    v_add_f32 v26, v26, v30
    v_add_f32 v19, v19, v23
    v_add_f32 v27, v27, v31
    v_cmp_ne_u32 vcc, s18, v52
    v_add_f32 v16, v16, v24
    v_add_f32 v17, v17, v25
    v_add_f32 v18, v18, v26
    v_add_f32 v19, v19, v27
    v_cvt_pk_bf16_f32 v20, v16, v17
    v_cvt_pk_bf16_f32 v21, v18, v19
    ds_write_b64 v15, v[20:21]
    s_cmp_eq_u64 vcc, 0
    s_cselect_b32 s13, 1, 2
    s_waitcnt lgkmcnt(0)
    s_mov_b64 exec, 1
    v_mov_b32 v6, 1
    ds_write_b32 v4, v6 offset:4
    s_mov_b64 exec, -1
    s_mov_b64 exec, 1
    v_mov_b32 v6, s13
    ds_write_b32 v4, v6 offset:20
    s_mov_b64 exec, -1
    s_cmp_eq_u32 s17, 1
    s_cbranch_scc1 L_qb2_7
    s_cmp_eq_u32 s13, 1
    s_cbranch_scc1 L_qb2_7
    s_add_u32 s16, s16, 2359296
    s_add_u32 s19, s19, 2359296
    buffer_store_dwordx4 v[36:39], v34, s[64:67], s16 offen sc1
    s_mov_b64 exec, 1
    buffer_store_dwordx4 v[40:43], v33, s[64:67], s19 offen sc1
    s_mov_b64 exec, -1
L_qb2_7:
L_cjoin:
    s_lshl_b32 s16, s76, 5
    s_mul_i32 s16, s16, 1152
    s_lshl_b32 s11, s14, 8
    s_add_u32 s16, s16, s11
    v_mul_u32_u24 v12, 9216, v3
    v_lshl_add_u32 v12, v2, 4, v12
    v_lshrrev_b32 v6, 5, v1
    v_bfe_u32 v7, v1, 2, 2
    v_lshl_add_u32 v7, v6, 2, v7
    v_bfe_u32 v15, v1, 4, 1
    v_and_b32 v16, 3, v1
    v_lshl_add_u32 v16, v15, 2, v16
    v_lshlrev_b32 v18, 7, v7
    v_lshl_add_u32 v17, v16, 4, v18
    s_lshl_b32 s20, s4, 3
    s_add_u32 s20, s20, s5
    s_lshl_b32 s20, s20, 10
    s_add_u32 s20, s20, 262144
    s_lshl_b32 s21, s4, 10
    s_lshl_b32 s10, s8, 4
    s_add_u32 s21, s21, s10
    s_add_u32 s21, s21, 524288
    v_lshrrev_b32 v21, 1, v3
    v_mul_u32_u24 v21, 18, v21
    v_lshrrev_b32 v22, 2, v2
    v_add_u32 v21, v21, v22
    v_mul_u32_u24 v21, 16640, v21
    v_and_b32 v22, 3, v2
    v_lshlrev_b32 v22, 1, v22
    v_and_b32 v23, 1, v3
    v_add_u32 v22, v22, v23
    v_lshl_add_u32 v21, v22, 4, v21
    s_mul_i32 s43, s6, 599040
    s_add_u32 s43, s43, 1048576
    s_lshl_b32 s22, s76, 7
    s_mul_i32 s10, s14, 66560
    s_add_u32 s22, s22, s43
    s_add_u32 s22, s22, s10
    v_bfe_u32 v22, v1, 3, 1
    v_lshlrev_b32 v22, 5, v22
    v_lshrrev_b32 v23, 1, v3
    v_lshl_add_u32 v22, v23, 4, v22
    v_and_b32 v23, 1, v3
    v_lshl_add_u32 v22, v23, 1, v22
    v_lshlrev_b32 v22, 2, v22
    v_add_u32 v23, 4, v22
    s_lshl_b32 s23, s6, 14
    s_lshl_b32 s10, s7, 8
    s_add_u32 s23, s23, s10
    s_add_u32 s23, s23, 655360
    v_lshlrev_b32 v19, 12, v1
    s_mul_i32 s27, s79, 0x100401
    s_mov_b32 s15, 400000
L_spin_8:
    ds_read_b32 v6, v4 offset:20
    s_waitcnt lgkmcnt(0)
    v_readfirstlane_b32 s10, v6
    s_nop 0
    s_cmp_ge_u32 s10, 1
    s_cbranch_scc1 L_done_9
    s_sub_u32 s15, s15, 1
    s_cbranch_scc0 L_spin_8
L_done_9:
    s_mov_b32 s24, s10
    s_cmp_eq_u32 s24, 1
    s_cbranch_scc1 L_ob_10
    s_add_u32 s20, s20, 2359296
    s_add_u32 s21, s21, 2359296
L_ob_10:
    s_mov_b32 s15, 400000
L_spin_11:
    ds_read_b32 v6, v4 offset:12
    s_waitcnt lgkmcnt(0)
    v_readfirstlane_b32 s10, v6
    s_nop 0
    s_cmp_ge_u32 s10, 4
    s_cbranch_scc1 L_done_12
    s_sub_u32 s15, s15, 1
    s_cbranch_scc0 L_spin_11
L_done_12:
    s_mov_b32 s12, s16
    buffer_load_dwordx4 v[80:83], v12, s[56:59], s12 offen nt
    s_add_u32 s12, s12, 1152
    buffer_load_dwordx4 v[84:87], v12, s[56:59], s12 offen nt
    s_add_u32 s12, s12, 1152
    buffer_load_dwordx4 v[88:91], v12, s[56:59], s12 offen nt
    s_add_u32 s12, s12, 1152
    buffer_load_dwordx4 v[92:95], v12, s[56:59], s12 offen nt
    s_add_u32 s12, s12, 1152
    buffer_load_dwordx4 v[96:99], v12, s[56:59], s12 offen nt
    s_add_u32 s12, s12, 1152
    buffer_load_dwordx4 v[100:103], v12, s[56:59], s12 offen nt
    s_add_u32 s12, s12, 1152
    buffer_load_dwordx4 v[104:107], v12, s[56:59], s12 offen nt
    s_add_u32 s12, s12, 1152
    buffer_load_dwordx4 v[108:111], v12, s[56:59], s12 offen nt
    s_cmp_lg_u32 s14, 0
    s_cbranch_scc1 L_nowo2
    s_mov_b32 exec_lo, 0x00ff00ff
    s_mov_b32 exec_hi, 0x00ff00ff
    s_add_u32 s12, s16, 1024
    buffer_load_dwordx4 v[112:115], v12, s[56:59], s12 offen nt
    s_add_u32 s12, s12, 1152
    buffer_load_dwordx4 v[116:119], v12, s[56:59], s12 offen nt
    s_add_u32 s12, s12, 1152
    buffer_load_dwordx4 v[120:123], v12, s[56:59], s12 offen nt
    s_add_u32 s12, s12, 1152
    buffer_load_dwordx4 v[124:127], v12, s[56:59], s12 offen nt
    s_add_u32 s12, s12, 1152
    buffer_load_dwordx4 v[128:131], v12, s[56:59], s12 offen nt
    s_add_u32 s12, s12, 1152
    buffer_load_dwordx4 v[132:135], v12, s[56:59], s12 offen nt
    s_add_u32 s12, s12, 1152
    buffer_load_dwordx4 v[136:139], v12, s[56:59], s12 offen nt
    s_add_u32 s12, s12, 1152
    buffer_load_dwordx4 v[140:143], v12, s[56:59], s12 offen nt
    s_mov_b64 exec, -1
L_nowo2:
    s_barrier
    s_mov_b32 s15, 400000
L_spin_13:
    ds_read_b32 v6, v4 offset:16
    s_waitcnt lgkmcnt(0)
    v_readfirstlane_b32 s10, v6
    s_nop 0
    s_cmp_ge_u32 s10, 1
    s_cbranch_scc1 L_done_14
    s_sub_u32 s15, s15, 1
    s_cbranch_scc0 L_spin_13
L_done_14:
    s_cmp_eq_u32 s24, 2
    s_cbranch_scc1 L_ob_15
    s_mov_b32 s15, 40000
L_poll_17:
    buffer_load_dwordx4 v[24:27], v17, s[64:67], s20 offen nt
    buffer_load_dwordx4 v[28:31], v18, s[64:67], s21 offen nt
    s_waitcnt vmcnt(0)
    v_xor_b32 v24, s79, v24
    v_xor_b32 v25, s79, v25
    v_xor_b32 v26, s79, v26
    v_xor_b32 v27, s79, v27
    v_xor_b32 v28, s79, v28
    v_xor_b32 v29, s79, v29
    v_xor_b32 v30, s79, v30
    v_xor_b32 v31, s79, v31
    v_or3_b32 v40, v24, v25, v26
    v_or3_b32 v41, v27, v28, v29
    v_or_b32 v42, v30, v31
    v_or3_b32 v43, v40, v41, v42
    v_and_b32 v44, 0x3ff, v43
    v_cmp_ne_u32 vcc, 0, v44
    s_nop 1
    s_cmp_eq_u64 vcc, 0
    s_cbranch_scc1 L_polld_18
    s_sub_u32 s15, s15, 1
    s_cbranch_scc0 L_poll_17
L_polld_18:
    s_branch L_od_16
L_ob_15:
    s_mov_b32 s15, 40000
L_poll_19:
    buffer_load_dwordx4 v[24:27], v17, s[64:67], s20 offen sc1
    buffer_load_dwordx4 v[28:31], v18, s[64:67], s21 offen sc1
    s_waitcnt vmcnt(0)
    v_xor_b32 v24, s79, v24
    v_xor_b32 v25, s79, v25
    v_xor_b32 v26, s79, v26
    v_xor_b32 v27, s79, v27
    v_xor_b32 v28, s79, v28
    v_xor_b32 v29, s79, v29
    v_xor_b32 v30, s79, v30
    v_xor_b32 v31, s79, v31
    v_or3_b32 v40, v24, v25, v26
    v_or3_b32 v41, v27, v28, v29
    v_or_b32 v42, v30, v31
    v_or3_b32 v43, v40, v41, v42
    v_and_b32 v44, 0x3ff, v43
    v_cmp_ne_u32 vcc, 0, v44
    s_nop 1
    s_cmp_eq_u64 vcc, 0
    s_cbranch_scc1 L_polld_20
    s_sub_u32 s15, s15, 1
    s_cbranch_scc0 L_poll_19
L_polld_20:
L_od_16:
    s_and_b32 s10, s5, 7
    s_cmp_lg_u32 s10, 0
    s_cbranch_scc1 L_hint_21
    s_cmp_lg_u32 s14, 1
    s_cbranch_scc1 L_hint_21
    s_mov_b64 exec, 15
    v_mov_b32 v6, s27
    buffer_store_dword v6, v19, s[64:67], s23 offen sc1
    s_mov_b64 exec, -1
L_hint_21:
    v_max_f32_dpp v30, v28, v28 row_ror:4 row_mask:0xf bank_mask:0xf
    s_nop 1
    v_max_f32_dpp v30, v30, v30 row_ror:8 row_mask:0xf bank_mask:0xf
    v_sub_f32 v31, v28, v30
    v_exp_f32 v31, v31
    s_nop 0
    v_mul_f32 v32, v31, v29
    v_mul_f32 v24, v24, v31
    v_mul_f32 v25, v25, v31
    v_add_f32_dpp v33, v32, v32 row_ror:4 row_mask:0xf bank_mask:0xf
    v_mul_f32 v26, v26, v31
    v_mul_f32 v27, v27, v31
    v_add_f32_dpp v33, v33, v33 row_ror:8 row_mask:0xf bank_mask:0xf
    v_add_f32_dpp v24, v24, v24 row_ror:4 row_mask:0xf bank_mask:0xf
    v_add_f32_dpp v25, v25, v25 row_ror:4 row_mask:0xf bank_mask:0xf
    v_add_f32_dpp v26, v26, v26 row_ror:4 row_mask:0xf bank_mask:0xf
    v_add_f32_dpp v27, v27, v27 row_ror:4 row_mask:0xf bank_mask:0xf
    v_rcp_f32 v33, v33
    v_add_f32_dpp v24, v24, v24 row_ror:8 row_mask:0xf bank_mask:0xf
    v_add_f32_dpp v25, v25, v25 row_ror:8 row_mask:0xf bank_mask:0xf
    v_add_f32_dpp v26, v26, v26 row_ror:8 row_mask:0xf bank_mask:0xf
    v_add_f32_dpp v27, v27, v27 row_ror:8 row_mask:0xf bank_mask:0xf
    v_mul_f32 v24, v24, v33
    v_mul_f32 v25, v25, v33
    v_mul_f32 v26, v26, v33
    v_mul_f32 v27, v27, v33
    v_cvt_pk_bf16_f32 v24, v24, v24
    v_cvt_pk_bf16_f32 v25, v25, v25
    v_cvt_pk_bf16_f32 v26, v26, v26
    v_cvt_pk_bf16_f32 v27, v27, v27
    ds_bpermute_b32 v32, v22, v24
    ds_bpermute_b32 v33, v22, v25
    ds_bpermute_b32 v34, v22, v26
    ds_bpermute_b32 v35, v22, v27
    ds_bpermute_b32 v36, v23, v24
    ds_bpermute_b32 v37, v23, v25
    ds_bpermute_b32 v38, v23, v26
    ds_bpermute_b32 v39, v23, v27
    s_cmp_lg_u32 s14, 0
    s_cbranch_scc1 L_op1
    s_waitcnt lgkmcnt(7)
    v_and_b32 v64, v8, v32
    v_and_b32 v65, v9, v32
    v_and_b32 v66, v10, v32
    v_and_b32 v67, v11, v32
    s_waitcnt lgkmcnt(6)
    v_and_b32 v68, v8, v33
    v_and_b32 v69, v9, v33
    v_and_b32 v70, v10, v33
    v_and_b32 v71, v11, v33
    v_mfma_f32_16x16x32_bf16 v[72:75], v[64:67], v[80:83], 0
    v_mfma_f32_16x16x32_bf16 v[76:79], v[64:67], v[112:115], 0
    s_waitcnt lgkmcnt(5)
    v_and_b32 v64, v8, v34
    v_and_b32 v65, v9, v34
    v_and_b32 v66, v10, v34
    v_and_b32 v67, v11, v34
    v_mfma_f32_16x16x32_bf16 v[72:75], v[68:71], v[84:87], v[72:75]
    v_mfma_f32_16x16x32_bf16 v[76:79], v[68:71], v[116:119], v[76:79]
    s_waitcnt lgkmcnt(4)
    v_and_b32 v68, v8, v35
    v_and_b32 v69, v9, v35
    v_and_b32 v70, v10, v35
    v_and_b32 v71, v11, v35
    v_mfma_f32_16x16x32_bf16 v[72:75], v[64:67], v[88:91], v[72:75]
    v_mfma_f32_16x16x32_bf16 v[76:79], v[64:67], v[120:123], v[76:79]
    s_waitcnt lgkmcnt(3)
    v_and_b32 v64, v8, v36
    v_and_b32 v65, v9, v36
    v_and_b32 v66, v10, v36
    v_and_b32 v67, v11, v36
    v_mfma_f32_16x16x32_bf16 v[72:75], v[68:71], v[92:95], v[72:75]
    v_mfma_f32_16x16x32_bf16 v[76:79], v[68:71], v[124:127], v[76:79]
    s_waitcnt lgkmcnt(2)
    v_and_b32 v68, v8, v37
    v_and_b32 v69, v9, v37
    v_and_b32 v70, v10, v37
    v_and_b32 v71, v11, v37
    v_mfma_f32_16x16x32_bf16 v[72:75], v[64:67], v[96:99], v[72:75]
    v_mfma_f32_16x16x32_bf16 v[76:79], v[64:67], v[128:131], v[76:79]
    s_waitcnt lgkmcnt(1)
    v_and_b32 v64, v8, v38
    v_and_b32 v65, v9, v38
    v_and_b32 v66, v10, v38
    v_and_b32 v67, v11, v38
    v_mfma_f32_16x16x32_bf16 v[72:75], v[68:71], v[100:103], v[72:75]
    v_mfma_f32_16x16x32_bf16 v[76:79], v[68:71], v[132:135], v[76:79]
    s_waitcnt lgkmcnt(0)
    v_and_b32 v68, v8, v39
    v_and_b32 v69, v9, v39
    v_and_b32 v70, v10, v39
    v_and_b32 v71, v11, v39
    v_mfma_f32_16x16x32_bf16 v[72:75], v[64:67], v[104:107], v[72:75]
    v_mfma_f32_16x16x32_bf16 v[76:79], v[64:67], v[136:139], v[76:79]
    s_nop 1
    v_mfma_f32_16x16x32_bf16 v[72:75], v[68:71], v[108:111], v[72:75]
    v_mfma_f32_16x16x32_bf16 v[76:79], v[68:71], v[140:143], v[76:79]
    s_nop 7
    v_add_u32 v72, 0x200, v72
    v_add_u32 v73, 0x200, v73
    v_add_u32 v74, 0x200, v74
    v_add_u32 v75, 0x200, v75
    v_and_or_b32 v72, v72, v62, s79
    v_and_or_b32 v73, v73, v62, s79
    v_and_or_b32 v74, v74, v62, s79
    v_and_or_b32 v75, v75, v62, s79
    buffer_store_dwordx4 v[72:75], v21, s[64:67], s22 offen sc1
    s_mov_b32 exec_lo, 0x00ff00ff
    s_mov_b32 exec_hi, 0x00ff00ff
    s_add_u32 s22, s22, 266240
    v_add_u32 v76, 0x200, v76
    v_add_u32 v77, 0x200, v77
    v_add_u32 v78, 0x200, v78
    v_add_u32 v79, 0x200, v79
    v_and_or_b32 v76, v76, v62, s79
    v_and_or_b32 v77, v77, v62, s79
    v_and_or_b32 v78, v78, v62, s79
    v_and_or_b32 v79, v79, v62, s79
    buffer_store_dwordx4 v[76:79], v21, s[64:67], s22 offen sc1
    s_branch L_cend
L_op1:
    s_waitcnt lgkmcnt(7)
    v_and_b32 v64, v8, v32
    v_and_b32 v65, v9, v32
    v_and_b32 v66, v10, v32
    v_and_b32 v67, v11, v32
    s_waitcnt lgkmcnt(6)
    v_and_b32 v68, v8, v33
    v_and_b32 v69, v9, v33
    v_and_b32 v70, v10, v33
    v_and_b32 v71, v11, v33
    v_mfma_f32_16x16x32_bf16 v[72:75], v[64:67], v[80:83], 0
    s_waitcnt lgkmcnt(5)
    v_and_b32 v64, v8, v34
    v_and_b32 v65, v9, v34
    v_and_b32 v66, v10, v34
    v_and_b32 v67, v11, v34
    v_mfma_f32_16x16x32_bf16 v[72:75], v[68:71], v[84:87], v[72:75]
    s_waitcnt lgkmcnt(4)
    v_and_b32 v68, v8, v35
    v_and_b32 v69, v9, v35
    v_and_b32 v70, v10, v35
    v_and_b32 v71, v11, v35
    v_mfma_f32_16x16x32_bf16 v[72:75], v[64:67], v[88:91], v[72:75]
    s_waitcnt lgkmcnt(3)
    v_and_b32 v64, v8, v36
    v_and_b32 v65, v9, v36
    v_and_b32 v66, v10, v36
    v_and_b32 v67, v11, v36
    v_mfma_f32_16x16x32_bf16 v[72:75], v[68:71], v[92:95], v[72:75]
    s_waitcnt lgkmcnt(2)
    v_and_b32 v68, v8, v37
    v_and_b32 v69, v9, v37
    v_and_b32 v70, v10, v37
    v_and_b32 v71, v11, v37
    v_mfma_f32_16x16x32_bf16 v[72:75], v[64:67], v[96:99], v[72:75]
    s_waitcnt lgkmcnt(1)
    v_and_b32 v64, v8, v38
    v_and_b32 v65, v9, v38
    v_and_b32 v66, v10, v38
    v_and_b32 v67, v11, v38
    v_mfma_f32_16x16x32_bf16 v[72:75], v[68:71], v[100:103], v[72:75]
    s_waitcnt lgkmcnt(0)
    v_and_b32 v68, v8, v39
    v_and_b32 v69, v9, v39
    v_and_b32 v70, v10, v39
    v_and_b32 v71, v11, v39
    v_mfma_f32_16x16x32_bf16 v[72:75], v[64:67], v[104:107], v[72:75]
    s_nop 1
    v_mfma_f32_16x16x32_bf16 v[72:75], v[68:71], v[108:111], v[72:75]
    s_nop 7
    v_add_u32 v72, 0x200, v72
    v_add_u32 v73, 0x200, v73
    v_add_u32 v74, 0x200, v74
    v_add_u32 v75, 0x200, v75
    v_and_or_b32 v72, v72, v62, s79
    v_and_or_b32 v73, v73, v62, s79
    v_and_or_b32 v74, v74, v62, s79
    v_and_or_b32 v75, v75, v62, s79
    buffer_store_dwordx4 v[72:75], v21, s[64:67], s22 offen sc1
    s_cmp_lg_u32 s14, 1
    s_cbranch_scc1 L_cend
    s_and_b32 s10, s76, 31
    s_cmp_ge_u32 s10, 9
    s_cbranch_scc1 L_cend
    s_lshr_b32 s11, s76, 5
    s_mul_i32 s11, s11, 9
    s_add_u32 s25, s10, s11
    s_mul_i32 s12, s25, 16640
    s_add_u32 s12, s12, s43
    s_add_u32 s13, s12, 4096
    s_add_u32 s16, s12, 8192
    s_add_u32 s17, s12, 12288
    s_cmp_ge_u32 s25, 18
    s_cselect_b32 s11, 18, 0
    s_cselect_b32 s26, 2304, 0
    s_sub_u32 s10, s25, s11
    s_lshl_b32 s10, s10, 6
    s_add_u32 s26, s26, s10
    s_mul_i32 s11, s6, 1152
    s_add_u32 s26, s26, s11
    v_lshlrev_b32 v15, 3, v1
    s_lshl_b32 s10, s6, 14
    s_add_u32 s20, s10, 655360
    s_and_b32 s10, s2, 3
    s_lshl_b32 s10, s10, 12
    s_add_u32 s20, s20, s10
    v_lshlrev_b32 v6, 8, v1
    s_mov_b64 exec, 0xffff
    s_mov_b32 s15, 40000
L_ha_22:
    buffer_load_dword v7, v6, s[64:67], s20 offen sc1
    s_waitcnt vmcnt(0)
    v_cmp_ne_u32 vcc, s27, v7
    s_nop 1
    s_and_b64 exec, exec, vcc
    s_cbranch_scc0 L_hd_23
    s_sub_u32 s15, s15, 1
    s_cbranch_scc0 L_ha_22
L_hd_23:
    s_mov_b64 exec, -1
    s_mov_b32 s15, 40000
L_poll_24:
    buffer_load_dwordx4 v[144:147], v14, s[64:67], s12 offen offset:0 sc1
    buffer_load_dwordx4 v[148:151], v14, s[64:67], s12 offen offset:1024 sc1
    buffer_load_dwordx4 v[152:155], v14, s[64:67], s12 offen offset:2048 sc1
    buffer_load_dwordx4 v[156:159], v14, s[64:67], s12 offen offset:3072 sc1
    buffer_load_dwordx4 v[160:163], v14, s[64:67], s13 offen offset:0 sc1
    buffer_load_dwordx4 v[164:167], v14, s[64:67], s13 offen offset:1024 sc1
    buffer_load_dwordx4 v[168:171], v14, s[64:67], s13 offen offset:2048 sc1
    buffer_load_dwordx4 v[172:175], v14, s[64:67], s13 offen offset:3072 sc1
    buffer_load_dwordx4 v[176:179], v14, s[64:67], s16 offen offset:0 sc1
    buffer_load_dwordx4 v[180:183], v14, s[64:67], s16 offen offset:1024 sc1
    buffer_load_dwordx4 v[184:187], v14, s[64:67], s16 offen offset:2048 sc1
    buffer_load_dwordx4 v[188:191], v14, s[64:67], s16 offen offset:3072 sc1
    buffer_load_dwordx4 v[192:195], v14, s[64:67], s17 offen offset:0 sc1
    buffer_load_dwordx4 v[196:199], v14, s[64:67], s17 offen offset:1024 sc1
    buffer_load_dwordx4 v[200:203], v14, s[64:67], s17 offen offset:2048 sc1
    buffer_load_dwordx4 v[204:207], v14, s[64:67], s17 offen offset:3072 sc1
    s_waitcnt vmcnt(15)
    v_xor_b32 v144, s79, v144
    v_xor_b32 v145, s79, v145
    v_xor_b32 v146, s79, v146
    v_xor_b32 v147, s79, v147
    v_or3_b32 v28, v144, v145, v146
    v_or_b32 v28, v28, v147
    s_waitcnt vmcnt(14)
    v_xor_b32 v148, s79, v148
    v_xor_b32 v149, s79, v149
    v_xor_b32 v150, s79, v150
    v_xor_b32 v151, s79, v151
    v_or3_b32 v28, v28, v148, v149
    v_or3_b32 v28, v28, v150, v151
    v_pk_add_f32 v[24:25], v[144:145], v[148:149]
    v_pk_add_f32 v[26:27], v[146:147], v[150:151]
    s_waitcnt vmcnt(13)
    v_xor_b32 v152, s79, v152
    v_xor_b32 v153, s79, v153
    v_xor_b32 v154, s79, v154
    v_xor_b32 v155, s79, v155
    v_or3_b32 v28, v28, v152, v153
    v_or3_b32 v28, v28, v154, v155
    v_pk_add_f32 v[24:25], v[24:25], v[152:153]
    v_pk_add_f32 v[26:27], v[26:27], v[154:155]
    s_waitcnt vmcnt(12)
    v_xor_b32 v156, s79, v156
    v_xor_b32 v157, s79, v157
    v_xor_b32 v158, s79, v158
    v_xor_b32 v159, s79, v159
    v_or3_b32 v28, v28, v156, v157
    v_or3_b32 v28, v28, v158, v159
    v_pk_add_f32 v[24:25], v[24:25], v[156:157]
    v_pk_add_f32 v[26:27], v[26:27], v[158:159]
    s_waitcnt vmcnt(11)
    v_xor_b32 v160, s79, v160
    v_xor_b32 v161, s79, v161
    v_xor_b32 v162, s79, v162
    v_xor_b32 v163, s79, v163
    v_or3_b32 v28, v28, v160, v161
    v_or3_b32 v28, v28, v162, v163
    v_pk_add_f32 v[24:25], v[24:25], v[160:161]
    v_pk_add_f32 v[26:27], v[26:27], v[162:163]
    s_waitcnt vmcnt(10)
    v_xor_b32 v164, s79, v164
    v_xor_b32 v165, s79, v165
    v_xor_b32 v166, s79, v166
    v_xor_b32 v167, s79, v167
    v_or3_b32 v28, v28, v164, v165
    v_or3_b32 v28, v28, v166, v167
    v_pk_add_f32 v[24:25], v[24:25], v[164:165]
    v_pk_add_f32 v[26:27], v[26:27], v[166:167]
    s_waitcnt vmcnt(9)
    v_xor_b32 v168, s79, v168
    v_xor_b32 v169, s79, v169
    v_xor_b32 v170, s79, v170
    v_xor_b32 v171, s79, v171
    v_or3_b32 v28, v28, v168, v169
    v_or3_b32 v28, v28, v170, v171
    v_pk_add_f32 v[24:25], v[24:25], v[168:169]
    v_pk_add_f32 v[26:27], v[26:27], v[170:171]
    s_waitcnt vmcnt(8)
    v_xor_b32 v172, s79, v172
    v_xor_b32 v173, s79, v173
    v_xor_b32 v174, s79, v174
    v_xor_b32 v175, s79, v175
    v_or3_b32 v28, v28, v172, v173
    v_or3_b32 v28, v28, v174, v175
    v_pk_add_f32 v[24:25], v[24:25], v[172:173]
    v_pk_add_f32 v[26:27], v[26:27], v[174:175]
    s_waitcnt vmcnt(7)
    v_xor_b32 v176, s79, v176
    v_xor_b32 v177, s79, v177
    v_xor_b32 v178, s79, v178
    v_xor_b32 v179, s79, v179
    v_or3_b32 v28, v28, v176, v177
    v_or3_b32 v28, v28, v178, v179
    v_pk_add_f32 v[24:25], v[24:25], v[176:177]
    v_pk_add_f32 v[26:27], v[26:27], v[178:179]
    s_waitcnt vmcnt(6)
    v_xor_b32 v180, s79, v180
    v_xor_b32 v181, s79, v181
    v_xor_b32 v182, s79, v182
    v_xor_b32 v183, s79, v183
    v_or3_b32 v28, v28, v180, v181
    v_or3_b32 v28, v28, v182, v183
    v_pk_add_f32 v[24:25], v[24:25], v[180:181]
    v_pk_add_f32 v[26:27], v[26:27], v[182:183]
    s_waitcnt vmcnt(5)
    v_xor_b32 v184, s79, v184
    v_xor_b32 v185, s79, v185
    v_xor_b32 v186, s79, v186
    v_xor_b32 v187, s79, v187
    v_or3_b32 v28, v28, v184, v185
    v_or3_b32 v28, v28, v186, v187
    v_pk_add_f32 v[24:25], v[24:25], v[184:185]
    v_pk_add_f32 v[26:27], v[26:27], v[186:187]
    s_waitcnt vmcnt(4)
    v_xor_b32 v188, s79, v188
    v_xor_b32 v189, s79, v189
    v_xor_b32 v190, s79, v190
    v_xor_b32 v191, s79, v191
    v_or3_b32 v28, v28, v188, v189
    v_or3_b32 v28, v28, v190, v191
    v_pk_add_f32 v[24:25], v[24:25], v[188:189]
    v_pk_add_f32 v[26:27], v[26:27], v[190:191]
    s_waitcnt vmcnt(3)
    v_xor_b32 v192, s79, v192
    v_xor_b32 v193, s79, v193
    v_xor_b32 v194, s79, v194
    v_xor_b32 v195, s79, v195
    v_or3_b32 v28, v28, v192, v193
    v_or3_b32 v28, v28, v194, v195
    v_pk_add_f32 v[24:25], v[24:25], v[192:193]
    v_pk_add_f32 v[26:27], v[26:27], v[194:195]
    s_waitcnt vmcnt(2)
    v_xor_b32 v196, s79, v196
    v_xor_b32 v197, s79, v197
    v_xor_b32 v198, s79, v198
    v_xor_b32 v199, s79, v199
    v_or3_b32 v28, v28, v196, v197
    v_or3_b32 v28, v28, v198, v199
    v_pk_add_f32 v[24:25], v[24:25], v[196:197]
    v_pk_add_f32 v[26:27], v[26:27], v[198:199]
    s_waitcnt vmcnt(1)
    v_xor_b32 v200, s79, v200
    v_xor_b32 v201, s79, v201
    v_xor_b32 v202, s79, v202
    v_xor_b32 v203, s79, v203
    v_or3_b32 v28, v28, v200, v201
    v_or3_b32 v28, v28, v202, v203
    v_pk_add_f32 v[24:25], v[24:25], v[200:201]
    v_pk_add_f32 v[26:27], v[26:27], v[202:203]
    s_waitcnt vmcnt(0)
    v_xor_b32 v204, s79, v204
    v_xor_b32 v205, s79, v205
    v_xor_b32 v206, s79, v206
    v_xor_b32 v207, s79, v207
    v_or3_b32 v28, v28, v204, v205
    v_or3_b32 v28, v28, v206, v207
    v_pk_add_f32 v[24:25], v[24:25], v[204:205]
    v_pk_add_f32 v[26:27], v[26:27], v[206:207]
    v_and_b32 v28, 0x3ff, v28
    v_cmp_ne_u32 vcc, 0, v28
    s_nop 1
    s_cmp_eq_u64 vcc, 0
    s_cbranch_scc1 L_polld_25
    s_sub_u32 s15, s15, 1
    s_cbranch_scc0 L_poll_24
L_polld_25:
    v_add_f32_dpp v24, v24, v24 row_ror:8 row_mask:0xf bank_mask:0xf
    v_add_f32_dpp v25, v25, v25 row_ror:8 row_mask:0xf bank_mask:0xf
    v_add_f32_dpp v26, v26, v26 row_ror:8 row_mask:0xf bank_mask:0xf
    v_add_f32_dpp v27, v27, v27 row_ror:8 row_mask:0xf bank_mask:0xf
    v_mov_b32 v32, v24
    v_mov_b32 v33, v25
    v_mov_b32 v34, v26
    v_mov_b32 v35, v27
    s_nop 0
    v_permlane16_swap_b32 v24, v32
    v_permlane16_swap_b32 v25, v33
    v_permlane16_swap_b32 v26, v34
    v_permlane16_swap_b32 v27, v35
    v_add_f32 v24, v24, v32
    v_add_f32 v25, v25, v33
    v_add_f32 v26, v26, v34
    v_add_f32 v27, v27, v35
    v_mov_b32 v32, v24
    v_mov_b32 v33, v25
    v_mov_b32 v34, v26
    v_mov_b32 v35, v27
    s_nop 0
    v_permlane32_swap_b32 v24, v32
    v_permlane32_swap_b32 v25, v33
    v_permlane32_swap_b32 v26, v34
    v_permlane32_swap_b32 v27, v35
    v_add_f32 v24, v24, v32
    v_add_f32 v25, v25, v33
    v_add_f32 v26, v26, v34
    v_add_f32 v27, v27, v35
    v_cvt_pk_bf16_f32 v32, v24, v25
    v_cvt_pk_bf16_f32 v33, v26, v27
    s_mov_b64 exec, 255
    buffer_store_dwordx2 v[32:33], v15, s[72:75], s26 offen
    s_cmp_lg_u32 s25, 0
    s_cbranch_scc1 L_cend
    s_lshl_b32 s10, s6, 8
    s_add_u32 s10, s10, 589824
    s_mov_b64 exec, 1
    v_mov_b32 v6, s79
    v_mov_b32 v7, 0
    buffer_store_dword v6, v7, s[64:67], s10 offen sc1
L_cend:
    s_endpgm
L_swave:
    s_mov_b32 s46, 67108864
    s_mov_b32 s47, 0x20000
    s_mov_b32 s50, 67108864
    s_mov_b32 s51, 0x20000
    s_lshl_b32 s10, s8, 4
    s_add_u32 s10, s10, s7
    s_lshl_b32 s10, s10, 21
    s_lshl_b32 s11, s9, 17
    s_add_u32 s10, s10, s11
    s_lshl_b32 s13, s14, 15
    s_add_u32 s10, s10, s13
    s_add_u32 s10, s10, 0x180000
    s_mul_i32 s11, s14, 1
    s_mul_i32 s12, s78, 2
    s_add_u32 s11, s11, s12
    s_add_u32 s12, s11, 0
    s_and_b32 s12, s12, 7
    s_lshl_b32 s12, s12, 12
    s_add_u32 s80, s12, s10
    s_add_u32 s12, s11, 1
    s_and_b32 s12, s12, 7
    s_lshl_b32 s12, s12, 12
    s_add_u32 s81, s12, s10
    s_add_u32 s12, s11, 2
    s_and_b32 s12, s12, 7
    s_lshl_b32 s12, s12, 12
    s_add_u32 s82, s12, s10
    s_add_u32 s12, s11, 3
    s_and_b32 s12, s12, 7
    s_lshl_b32 s12, s12, 12
    s_add_u32 s83, s12, s10
    s_add_u32 s12, s11, 4
    s_and_b32 s12, s12, 7
    s_lshl_b32 s12, s12, 12
    s_add_u32 s84, s12, s10
    s_add_u32 s12, s11, 5
    s_and_b32 s12, s12, 7
    s_lshl_b32 s12, s12, 12
    s_add_u32 s85, s12, s10
    s_add_u32 s12, s11, 6
    s_and_b32 s12, s12, 7
    s_lshl_b32 s12, s12, 12
    s_add_u32 s86, s12, s10
    s_add_u32 s12, s11, 7
    s_and_b32 s12, s12, 7
    s_lshl_b32 s12, s12, 12
    s_add_u32 s87, s12, s10
    v_lshlrev_b32 v6, 2, v3
    v_xor_b32 v6, v6, v2
    v_lshlrev_b32 v6, 4, v6
    v_lshl_add_u32 v12, v3, 8, v6
    v_xor_b32 v13, 16, v12
    v_xor_b32 v14, 32, v12
    v_xor_b32 v15, 48, v12
    v_lshlrev_b32 v20, 4, v1
    s_mov_b32 m0, s13
    s_cmp_eq_u32 s6, 0
    s_waitcnt lgkmcnt(0)
    s_cselect_b32 s44, s18, s28
    s_cselect_b32 s45, s19, s29
    s_cselect_b32 s48, s20, s30
    s_cselect_b32 s49, s21, s31
    s_barrier
    buffer_load_dwordx4 v12, s[44:47], s80 offen offset:0 nt lds
    buffer_load_dwordx4 v13, s[44:47], s80 offen offset:1024 nt lds
    buffer_load_dwordx4 v14, s[44:47], s80 offen offset:2048 nt lds
    buffer_load_dwordx4 v15, s[44:47], s80 offen offset:3072 nt lds
    s_add_u32 m0, s13, 4096
    s_nop 0
    buffer_load_dwordx4 v12, s[44:47], s81 offen offset:0 nt lds
    s_mov_b32 s64, s40
    s_mov_b32 s65, s41
    s_lshl_b32 s10, s6, 8
    s_add_u32 s10, s10, 589824
    s_load_dword s79, s[40:41], s10
    s_waitcnt vmcnt(4)
    buffer_load_dwordx4 v13, s[44:47], s81 offen offset:1024 nt lds
    s_waitcnt vmcnt(4)
    buffer_load_dwordx4 v14, s[44:47], s81 offen offset:2048 nt lds
    s_waitcnt vmcnt(4)
    buffer_load_dwordx4 v15, s[44:47], s81 offen offset:3072 nt lds
    s_waitcnt vmcnt(4)
    s_add_u32 m0, s13, 8192
    s_nop 0
    buffer_load_dwordx4 v12, s[44:47], s82 offen offset:0 nt lds
    s_waitcnt vmcnt(4)
    buffer_load_dwordx4 v13, s[44:47], s82 offen offset:1024 nt lds
    s_waitcnt vmcnt(4)
    buffer_load_dwordx4 v14, s[44:47], s82 offen offset:2048 nt lds
    s_waitcnt vmcnt(4)
    buffer_load_dwordx4 v15, s[44:47], s82 offen offset:3072 nt lds
    s_waitcnt vmcnt(4)
    s_add_u32 m0, s13, 12288
    s_nop 0
    buffer_load_dwordx4 v12, s[44:47], s83 offen offset:0 nt lds
    s_waitcnt vmcnt(4)
    buffer_load_dwordx4 v13, s[44:47], s83 offen offset:1024 nt lds
    s_waitcnt vmcnt(4)
    buffer_load_dwordx4 v14, s[44:47], s83 offen offset:2048 nt lds
    s_waitcnt vmcnt(4)
    buffer_load_dwordx4 v15, s[44:47], s83 offen offset:3072 nt lds
    s_waitcnt vmcnt(4)
    s_add_u32 m0, s13, 16384
    s_nop 0
    buffer_load_dwordx4 v12, s[44:47], s84 offen offset:0 nt lds
    s_waitcnt vmcnt(4)
    buffer_load_dwordx4 v13, s[44:47], s84 offen offset:1024 nt lds
    s_waitcnt vmcnt(4)
    buffer_load_dwordx4 v14, s[44:47], s84 offen offset:2048 nt lds
    s_waitcnt vmcnt(4)
    buffer_load_dwordx4 v15, s[44:47], s84 offen offset:3072 nt lds
    s_waitcnt vmcnt(4)
    s_add_u32 m0, s13, 20480
    s_nop 0
    buffer_load_dwordx4 v12, s[44:47], s85 offen offset:0 nt lds
    s_waitcnt vmcnt(4)
    buffer_load_dwordx4 v13, s[44:47], s85 offen offset:1024 nt lds
    s_waitcnt vmcnt(4)
    buffer_load_dwordx4 v14, s[44:47], s85 offen offset:2048 nt lds
    s_waitcnt vmcnt(4)
    buffer_load_dwordx4 v15, s[44:47], s85 offen offset:3072 nt lds
    s_waitcnt vmcnt(4)
    s_add_u32 m0, s13, 24576
    s_nop 0
    buffer_load_dwordx4 v12, s[44:47], s86 offen offset:0 nt lds
    s_waitcnt vmcnt(4)
    buffer_load_dwordx4 v13, s[44:47], s86 offen offset:1024 nt lds
    s_waitcnt vmcnt(4)
    buffer_load_dwordx4 v14, s[44:47], s86 offen offset:2048 nt lds
    s_waitcnt vmcnt(4)
    buffer_load_dwordx4 v15, s[44:47], s86 offen offset:3072 nt lds
    s_waitcnt vmcnt(4)
    s_add_u32 m0, s13, 28672
    s_nop 0
    buffer_load_dwordx4 v12, s[44:47], s87 offen offset:0 nt lds
    s_waitcnt vmcnt(4)
    buffer_load_dwordx4 v13, s[44:47], s87 offen offset:1024 nt lds
    s_waitcnt vmcnt(4)
    buffer_load_dwordx4 v14, s[44:47], s87 offen offset:2048 nt lds
    s_waitcnt vmcnt(4)
    buffer_load_dwordx4 v15, s[44:47], s87 offen offset:3072 nt lds
    s_waitcnt vmcnt(4)
    buffer_load_dwordx4 v[128:131], v20, s[48:51], s80 offen offset:0 nt
    s_waitcnt vmcnt(4)
    buffer_load_dwordx4 v[132:135], v20, s[48:51], s80 offen offset:1024 nt
    s_waitcnt vmcnt(4)
    buffer_load_dwordx4 v[136:139], v20, s[48:51], s80 offen offset:2048 nt
    s_waitcnt vmcnt(4)
    buffer_load_dwordx4 v[140:143], v20, s[48:51], s80 offen offset:3072 nt
    s_waitcnt vmcnt(4)
    v_and_b32 v6, 1, v1
    v_lshlrev_b32 v6, 4, v6
    v_mov_b32 v7, 0xffff
    v_lshlrev_b32 v7, v6, v7
    v_bfe_u32 v6, v1, 1, 2
    v_cmp_eq_u32 vcc, 0, v6
    s_nop 1
    v_cndmask_b32 v8, 0, v7, vcc
    v_cmp_eq_u32 vcc, 1, v6
    s_nop 1
    v_cndmask_b32 v9, 0, v7, vcc
    v_cmp_eq_u32 vcc, 2, v6
    s_nop 1
    v_cndmask_b32 v10, 0, v7, vcc
    v_cmp_eq_u32 vcc, 3, v6
    s_nop 1
    v_cndmask_b32 v11, 0, v7, vcc
    v_and_b32 v6, 3, v2
    v_lshlrev_b32 v6, 2, v6
    v_lshrrev_b32 v7, 2, v2
    v_add_u32 v6, v6, v7
    v_lshlrev_b32 v6, 8, v6
    v_xor_b32 v7, v3, v2
    v_lshl_add_u32 v6, v7, 4, v6
    v_add_u32 v16, s13, v6
    v_xor_b32 v17, 64, v16
    v_xor_b32 v18, 128, v16
    v_xor_b32 v19, 192, v16
    s_mov_b32 s77, 0x3e0293ee
    v_bfe_u32 v21, v1, 3, 1
    v_lshlrev_b32 v22, 8, v21
    v_lshl_add_u32 v22, v3, 4, v22
    v_add_u32 v22, 131328, v22
    v_lshl_add_u32 v23, v21, 4, v4
    s_lshl_b32 s12, s14, 2
    v_add_u32 v21, s12, v23
    v_lshrrev_b32 v6, 1, v3
    v_lshlrev_b32 v6, 2, v6
    v_lshrrev_b32 v7, 2, v2
    v_add_u32 v6, v6, v7
    v_lshlrev_b32 v6, 10, v6
    v_and_b32 v7, 3, v2
    v_lshl_add_u32 v6, v7, 5, v6
    v_and_b32 v7, 1, v3
    v_lshl_add_u32 v124, v7, 4, v6
    v_lshlrev_b32 v125, 2, v1
    s_lshl_b32 s10, s4, 13
    s_lshl_b32 s11, s5, 7
    s_add_u32 s10, s10, s11
    s_add_u32 s18, s10, 262144
    s_lshl_b32 s10, s4, 10
    s_add_u32 s10, s10, s11
    s_add_u32 s19, s10, 524288
    s_lshl_b32 s10, s14, 10
    v_add_u32 v126, s10, v20
    v_add_u32 v126, 139264, v126
    v_add_u32 v127, 139264, v20
    v_mov_b32 v5, 0xfffffc00
    s_waitcnt lgkmcnt(0)
    s_add_u32 s79, s79, 1
    s_and_b32 s79, s79, 0x3ff
    s_mov_b32 s15, 400000
L_spin_26:
    ds_read_b32 v6, v4 offset:4
    s_waitcnt lgkmcnt(0)
    v_readfirstlane_b32 s10, v6
    s_nop 0
    s_cmp_ge_u32 s10, 1
    s_cbranch_scc1 L_done_27
    s_sub_u32 s15, s15, 1
    s_cbranch_scc0 L_spin_26
L_done_27:
    ds_read_b128 v[24:27], v22 offset:0
    ds_read_b128 v[28:31], v22 offset:64
    ds_read_b128 v[32:35], v22 offset:128
    ds_read_b128 v[36:39], v22 offset:192
    buffer_load_dwordx4 v[144:147], v20, s[48:51], s81 offen offset:0 nt
    buffer_load_dwordx4 v[148:151], v20, s[48:51], s81 offen offset:1024 nt
    buffer_load_dwordx4 v[152:155], v20, s[48:51], s81 offen offset:2048 nt
    buffer_load_dwordx4 v[156:159], v20, s[48:51], s81 offen offset:3072 nt
    s_waitcnt vmcnt(8)
    ds_read_b128 v[40:43], v16 offset:0
    ds_read_b128 v[44:47], v17 offset:0
    ds_read_b128 v[48:51], v18 offset:0
    ds_read_b128 v[52:55], v19 offset:0
    ds_read_b128 v[56:59], v16 offset:4096
    ds_read_b128 v[60:63], v17 offset:4096
    ds_read_b128 v[64:67], v18 offset:4096
    ds_read_b128 v[68:71], v19 offset:4096
    s_waitcnt lgkmcnt(4)
    v_mfma_f32_16x16x32_bf16 v[72:75], v[40:43], v[24:27], 0
    v_mfma_f32_16x16x32_bf16 v[72:75], v[44:47], v[28:31], v[72:75]
    v_mfma_f32_16x16x32_bf16 v[72:75], v[48:51], v[32:35], v[72:75]
    v_mfma_f32_16x16x32_bf16 v[72:75], v[52:55], v[36:39], v[72:75]
    ds_read_b128 v[40:43], v16 offset:8192
    ds_read_b128 v[44:47], v17 offset:8192
    ds_read_b128 v[48:51], v18 offset:8192
    ds_read_b128 v[52:55], v19 offset:8192
    s_waitcnt lgkmcnt(4)
    v_mfma_f32_16x16x32_bf16 v[76:79], v[56:59], v[24:27], 0
    v_mfma_f32_16x16x32_bf16 v[76:79], v[60:63], v[28:31], v[76:79]
    v_mfma_f32_16x16x32_bf16 v[76:79], v[64:67], v[32:35], v[76:79]
    v_mfma_f32_16x16x32_bf16 v[76:79], v[68:71], v[36:39], v[76:79]
    buffer_load_dwordx4 v[160:163], v20, s[48:51], s82 offen offset:0 nt
    ds_read_b128 v[56:59], v16 offset:12288
    ds_read_b128 v[60:63], v17 offset:12288
    ds_read_b128 v[64:67], v18 offset:12288
    ds_read_b128 v[68:71], v19 offset:12288
    s_waitcnt lgkmcnt(4)
    v_mfma_f32_16x16x32_bf16 v[80:83], v[40:43], v[24:27], 0
    v_mfma_f32_16x16x32_bf16 v[80:83], v[44:47], v[28:31], v[80:83]
    v_mfma_f32_16x16x32_bf16 v[80:83], v[48:51], v[32:35], v[80:83]
    v_mfma_f32_16x16x32_bf16 v[80:83], v[52:55], v[36:39], v[80:83]
    ds_read_b128 v[40:43], v16 offset:16384
    ds_read_b128 v[44:47], v17 offset:16384
    ds_read_b128 v[48:51], v18 offset:16384
    ds_read_b128 v[52:55], v19 offset:16384
    s_waitcnt lgkmcnt(4)
    v_mfma_f32_16x16x32_bf16 v[84:87], v[56:59], v[24:27], 0
    v_mfma_f32_16x16x32_bf16 v[84:87], v[60:63], v[28:31], v[84:87]
    v_mfma_f32_16x16x32_bf16 v[84:87], v[64:67], v[32:35], v[84:87]
    v_mfma_f32_16x16x32_bf16 v[84:87], v[68:71], v[36:39], v[84:87]
    buffer_load_dwordx4 v[164:167], v20, s[48:51], s82 offen offset:1024 nt
    ds_read_b128 v[56:59], v16 offset:20480
    ds_read_b128 v[60:63], v17 offset:20480
    ds_read_b128 v[64:67], v18 offset:20480
    ds_read_b128 v[68:71], v19 offset:20480
    s_waitcnt lgkmcnt(4)
    v_mfma_f32_16x16x32_bf16 v[88:91], v[40:43], v[24:27], 0
    v_mfma_f32_16x16x32_bf16 v[88:91], v[44:47], v[28:31], v[88:91]
    v_mfma_f32_16x16x32_bf16 v[88:91], v[48:51], v[32:35], v[88:91]
    v_mfma_f32_16x16x32_bf16 v[88:91], v[52:55], v[36:39], v[88:91]
    ds_read_b128 v[40:43], v16 offset:24576
    ds_read_b128 v[44:47], v17 offset:24576
    ds_read_b128 v[48:51], v18 offset:24576
    ds_read_b128 v[52:55], v19 offset:24576
    s_waitcnt lgkmcnt(4)
    v_mfma_f32_16x16x32_bf16 v[92:95], v[56:59], v[24:27], 0
    v_mfma_f32_16x16x32_bf16 v[92:95], v[60:63], v[28:31], v[92:95]
    v_mfma_f32_16x16x32_bf16 v[92:95], v[64:67], v[32:35], v[92:95]
    v_mfma_f32_16x16x32_bf16 v[92:95], v[68:71], v[36:39], v[92:95]
    buffer_load_dwordx4 v[168:171], v20, s[48:51], s82 offen offset:2048 nt
    ds_read_b128 v[56:59], v16 offset:28672
    ds_read_b128 v[60:63], v17 offset:28672
    ds_read_b128 v[64:67], v18 offset:28672
    ds_read_b128 v[68:71], v19 offset:28672
    s_waitcnt lgkmcnt(4)
    v_mfma_f32_16x16x32_bf16 v[96:99], v[40:43], v[24:27], 0
    v_mfma_f32_16x16x32_bf16 v[96:99], v[44:47], v[28:31], v[96:99]
    v_mfma_f32_16x16x32_bf16 v[96:99], v[48:51], v[32:35], v[96:99]
    v_mfma_f32_16x16x32_bf16 v[96:99], v[52:55], v[36:39], v[96:99]
    s_waitcnt lgkmcnt(0)
    v_mfma_f32_16x16x32_bf16 v[100:103], v[56:59], v[24:27], 0
    v_mfma_f32_16x16x32_bf16 v[100:103], v[60:63], v[28:31], v[100:103]
    v_mfma_f32_16x16x32_bf16 v[100:103], v[64:67], v[32:35], v[100:103]
    v_mfma_f32_16x16x32_bf16 v[100:103], v[68:71], v[36:39], v[100:103]
    buffer_load_dwordx4 v[172:175], v20, s[48:51], s82 offen offset:3072 nt
    s_nop 7
    v_max3_f32 v116, v72, v73, v74
    v_max3_f32 v117, v75, v76, v77
    v_max3_f32 v116, v116, v78, v79
    v_max3_f32 v117, v117, v80, v81
    v_max3_f32 v116, v116, v82, v83
    v_max3_f32 v117, v117, v84, v85
    v_max3_f32 v116, v116, v86, v87
    v_max3_f32 v117, v117, v88, v89
    v_max3_f32 v116, v116, v90, v91
    v_max3_f32 v117, v117, v92, v93
    v_max3_f32 v116, v116, v94, v95
    v_max3_f32 v117, v117, v96, v97
    v_max3_f32 v116, v116, v98, v99
    v_max3_f32 v117, v117, v100, v101
    v_max3_f32 v116, v116, v102, v103
    v_max_f32 v116, v116, v117
    s_nop 0
    v_mov_b32 v117, v116
    s_nop 1
    v_permlane16_swap_b32 v116, v117
    v_max_f32 v116, v116, v117
    s_nop 0
    v_mov_b32 v117, v116
    s_nop 1
    v_permlane32_swap_b32 v116, v117
    v_max_f32 v116, v116, v117
    s_mov_b64 exec, 0x101
    ds_write_b32 v21, v116 offset:64
    s_mov_b64 exec, -1
    s_waitcnt lgkmcnt(0)
    s_mov_b64 exec, 1
    v_mov_b32 v6, 1
    ds_add_u32 v4, v6 offset:8
    s_mov_b64 exec, -1
    buffer_load_dwordx4 v[176:179], v20, s[48:51], s83 offen offset:0 nt
    v_mul_f32 v116, s77, v116
    v_add_u32 v116, 0x200, v116
    v_and_b32 v116, v5, v116
    v_mov_b32 v118, 0
    v_mov_b32 v119, 0
    v_fma_f32 v72, v72, s77, -v116
    v_fma_f32 v73, v73, s77, -v116
    v_fma_f32 v74, v74, s77, -v116
    v_fma_f32 v75, v75, s77, -v116
    v_exp_f32 v72, v72
    v_exp_f32 v73, v73
    v_exp_f32 v74, v74
    v_exp_f32 v75, v75
    buffer_load_dwordx4 v[180:183], v20, s[48:51], s83 offen offset:1024 nt
    v_add_f32 v118, v118, v72
    v_add_f32 v119, v119, v73
    v_add_f32 v118, v118, v74
    v_add_f32 v119, v119, v75
    v_cvt_pk_bf16_f32 v72, v72, v72
    v_cvt_pk_bf16_f32 v73, v73, v73
    v_cvt_pk_bf16_f32 v74, v74, v74
    v_cvt_pk_bf16_f32 v75, v75, v75
    v_fma_f32 v76, v76, s77, -v116
    v_fma_f32 v77, v77, s77, -v116
    v_fma_f32 v78, v78, s77, -v116
    v_fma_f32 v79, v79, s77, -v116
    v_exp_f32 v76, v76
    v_exp_f32 v77, v77
    v_exp_f32 v78, v78
    v_exp_f32 v79, v79
    buffer_load_dwordx4 v[184:187], v20, s[48:51], s83 offen offset:2048 nt
    v_add_f32 v118, v118, v76
    v_add_f32 v119, v119, v77
    v_add_f32 v118, v118, v78
    v_add_f32 v119, v119, v79
    v_cvt_pk_bf16_f32 v76, v76, v76
    v_cvt_pk_bf16_f32 v77, v77, v77
    v_cvt_pk_bf16_f32 v78, v78, v78
    v_cvt_pk_bf16_f32 v79, v79, v79
    v_fma_f32 v80, v80, s77, -v116
    v_fma_f32 v81, v81, s77, -v116
    v_fma_f32 v82, v82, s77, -v116
    v_fma_f32 v83, v83, s77, -v116
    v_exp_f32 v80, v80
    v_exp_f32 v81, v81
    v_exp_f32 v82, v82
    v_exp_f32 v83, v83
    buffer_load_dwordx4 v[188:191], v20, s[48:51], s83 offen offset:3072 nt
    v_add_f32 v118, v118, v80
    v_add_f32 v119, v119, v81
    v_add_f32 v118, v118, v82
    v_add_f32 v119, v119, v83
    v_cvt_pk_bf16_f32 v80, v80, v80
    v_cvt_pk_bf16_f32 v81, v81, v81
    v_cvt_pk_bf16_f32 v82, v82, v82
    v_cvt_pk_bf16_f32 v83, v83, v83
    v_fma_f32 v84, v84, s77, -v116
    v_fma_f32 v85, v85, s77, -v116
    v_fma_f32 v86, v86, s77, -v116
    v_fma_f32 v87, v87, s77, -v116
    v_exp_f32 v84, v84
    v_exp_f32 v85, v85
    v_exp_f32 v86, v86
    v_exp_f32 v87, v87
    buffer_load_dwordx4 v[192:195], v20, s[48:51], s84 offen offset:0 nt
    v_add_f32 v118, v118, v84
    v_add_f32 v119, v119, v85
    v_add_f32 v118, v118, v86
    v_add_f32 v119, v119, v87
    v_cvt_pk_bf16_f32 v84, v84, v84
    v_cvt_pk_bf16_f32 v85, v85, v85
    v_cvt_pk_bf16_f32 v86, v86, v86
    v_cvt_pk_bf16_f32 v87, v87, v87
    v_fma_f32 v88, v88, s77, -v116
    v_fma_f32 v89, v89, s77, -v116
    v_fma_f32 v90, v90, s77, -v116
    v_fma_f32 v91, v91, s77, -v116
    v_exp_f32 v88, v88
    v_exp_f32 v89, v89
    v_exp_f32 v90, v90
    v_exp_f32 v91, v91
    buffer_load_dwordx4 v[196:199], v20, s[48:51], s84 offen offset:1024 nt
    v_add_f32 v118, v118, v88
    v_add_f32 v119, v119, v89
    v_add_f32 v118, v118, v90
    v_add_f32 v119, v119, v91
    v_cvt_pk_bf16_f32 v88, v88, v88
    v_cvt_pk_bf16_f32 v89, v89, v89
    v_cvt_pk_bf16_f32 v90, v90, v90
    v_cvt_pk_bf16_f32 v91, v91, v91
    v_fma_f32 v92, v92, s77, -v116
    v_fma_f32 v93, v93, s77, -v116
    v_fma_f32 v94, v94, s77, -v116
    v_fma_f32 v95, v95, s77, -v116
    v_exp_f32 v92, v92
    v_exp_f32 v93, v93
    v_exp_f32 v94, v94
    v_exp_f32 v95, v95
    buffer_load_dwordx4 v[200:203], v20, s[48:51], s84 offen offset:2048 nt
    v_add_f32 v118, v118, v92
    v_add_f32 v119, v119, v93
    v_add_f32 v118, v118, v94
    v_add_f32 v119, v119, v95
    v_cvt_pk_bf16_f32 v92, v92, v92
    v_cvt_pk_bf16_f32 v93, v93, v93
    v_cvt_pk_bf16_f32 v94, v94, v94
    v_cvt_pk_bf16_f32 v95, v95, v95
    v_fma_f32 v96, v96, s77, -v116
    v_fma_f32 v97, v97, s77, -v116
    v_fma_f32 v98, v98, s77, -v116
    v_fma_f32 v99, v99, s77, -v116
    v_exp_f32 v96, v96
    v_exp_f32 v97, v97
    v_exp_f32 v98, v98
    v_exp_f32 v99, v99
    buffer_load_dwordx4 v[204:207], v20, s[48:51], s84 offen offset:3072 nt
    v_add_f32 v118, v118, v96
    v_add_f32 v119, v119, v97
    v_add_f32 v118, v118, v98
    v_add_f32 v119, v119, v99
    v_cvt_pk_bf16_f32 v96, v96, v96
    v_cvt_pk_bf16_f32 v97, v97, v97
    v_cvt_pk_bf16_f32 v98, v98, v98
    v_cvt_pk_bf16_f32 v99, v99, v99
    v_fma_f32 v100, v100, s77, -v116
    v_fma_f32 v101, v101, s77, -v116
    v_fma_f32 v102, v102, s77, -v116
    v_fma_f32 v103, v103, s77, -v116
    v_exp_f32 v100, v100
    v_exp_f32 v101, v101
    v_exp_f32 v102, v102
    v_exp_f32 v103, v103
    buffer_load_dwordx4 v[208:211], v20, s[48:51], s85 offen offset:0 nt
    v_add_f32 v118, v118, v100
    v_add_f32 v119, v119, v101
    v_add_f32 v118, v118, v102
    v_add_f32 v119, v119, v103
    v_cvt_pk_bf16_f32 v100, v100, v100
    v_cvt_pk_bf16_f32 v101, v101, v101
    v_cvt_pk_bf16_f32 v102, v102, v102
    v_cvt_pk_bf16_f32 v103, v103, v103
    v_add_f32 v118, v118, v119
    s_nop 0
    v_mov_b32 v119, v118
    s_nop 1
    v_permlane16_swap_b32 v118, v119
    v_add_f32 v118, v118, v119
    s_nop 0
    v_mov_b32 v119, v118
    s_nop 1
    v_permlane32_swap_b32 v118, v119
    v_add_f32 v118, v118, v119
    v_and_b32 v104, v8, v72
    v_and_b32 v105, v9, v72
    v_and_b32 v106, v10, v72
    v_and_b32 v107, v11, v72
    s_waitcnt vmcnt(4)
    buffer_load_dwordx4 v[212:215], v20, s[48:51], s85 offen offset:1024 nt
    v_and_b32 v108, v8, v73
    v_and_b32 v109, v9, v73
    v_and_b32 v110, v10, v73
    v_and_b32 v111, v11, v73
    v_mfma_f32_16x16x32_bf16 v[112:115], v[104:107], v[128:131], 0
    v_and_b32 v104, v8, v74
    v_and_b32 v105, v9, v74
    v_and_b32 v106, v10, v74
    v_and_b32 v107, v11, v74
    v_mfma_f32_16x16x32_bf16 v[112:115], v[108:111], v[132:135], v[112:115]
    s_waitcnt vmcnt(4)
    buffer_load_dwordx4 v[216:219], v20, s[48:51], s85 offen offset:2048 nt
    v_and_b32 v108, v8, v75
    v_and_b32 v109, v9, v75
    v_and_b32 v110, v10, v75
    v_and_b32 v111, v11, v75
    v_mfma_f32_16x16x32_bf16 v[112:115], v[104:107], v[136:139], v[112:115]
    v_and_b32 v104, v8, v76
    v_and_b32 v105, v9, v76
    v_and_b32 v106, v10, v76
    v_and_b32 v107, v11, v76
    v_mfma_f32_16x16x32_bf16 v[112:115], v[108:111], v[140:143], v[112:115]
    s_waitcnt vmcnt(4)
    buffer_load_dwordx4 v[220:223], v20, s[48:51], s85 offen offset:3072 nt
    v_and_b32 v108, v8, v77
    v_and_b32 v109, v9, v77
    v_and_b32 v110, v10, v77
    v_and_b32 v111, v11, v77
    v_mfma_f32_16x16x32_bf16 v[112:115], v[104:107], v[144:147], v[112:115]
    v_and_b32 v104, v8, v78
    v_and_b32 v105, v9, v78
    v_and_b32 v106, v10, v78
    v_and_b32 v107, v11, v78
    v_mfma_f32_16x16x32_bf16 v[112:115], v[108:111], v[148:151], v[112:115]
    s_waitcnt vmcnt(4)
    buffer_load_dwordx4 v[224:227], v20, s[48:51], s86 offen offset:0 nt
    v_and_b32 v108, v8, v79
    v_and_b32 v109, v9, v79
    v_and_b32 v110, v10, v79
    v_and_b32 v111, v11, v79
    v_mfma_f32_16x16x32_bf16 v[112:115], v[104:107], v[152:155], v[112:115]
    v_and_b32 v104, v8, v80
    v_and_b32 v105, v9, v80
    v_and_b32 v106, v10, v80
    v_and_b32 v107, v11, v80
    v_mfma_f32_16x16x32_bf16 v[112:115], v[108:111], v[156:159], v[112:115]
    s_waitcnt vmcnt(4)
    buffer_load_dwordx4 v[228:231], v20, s[48:51], s86 offen offset:1024 nt
    v_and_b32 v108, v8, v81
    v_and_b32 v109, v9, v81
    v_and_b32 v110, v10, v81
    v_and_b32 v111, v11, v81
    v_mfma_f32_16x16x32_bf16 v[112:115], v[104:107], v[160:163], v[112:115]
    v_and_b32 v104, v8, v82
    v_and_b32 v105, v9, v82
    v_and_b32 v106, v10, v82
    v_and_b32 v107, v11, v82
    v_mfma_f32_16x16x32_bf16 v[112:115], v[108:111], v[164:167], v[112:115]
    s_waitcnt vmcnt(4)
    buffer_load_dwordx4 v[232:235], v20, s[48:51], s86 offen offset:2048 nt
    v_and_b32 v108, v8, v83
    v_and_b32 v109, v9, v83
    v_and_b32 v110, v10, v83
    v_and_b32 v111, v11, v83
    v_mfma_f32_16x16x32_bf16 v[112:115], v[104:107], v[168:171], v[112:115]
    v_and_b32 v104, v8, v84
    v_and_b32 v105, v9, v84
    v_and_b32 v106, v10, v84
    v_and_b32 v107, v11, v84
    v_mfma_f32_16x16x32_bf16 v[112:115], v[108:111], v[172:175], v[112:115]
    s_waitcnt vmcnt(4)
    buffer_load_dwordx4 v[236:239], v20, s[48:51], s86 offen offset:3072 nt
    s_mov_b32 s15, 400000
L_spin_28:
    ds_read_b32 v6, v4 offset:8
    s_waitcnt lgkmcnt(0)
    v_readfirstlane_b32 s10, v6
    s_nop 0
    s_cmp_ge_u32 s10, 4
    s_cbranch_scc1 L_done_29
    s_sub_u32 s15, s15, 1
    s_cbranch_scc0 L_spin_28
L_done_29:
    v_lshrrev_b32 v6, 5, v1
    v_lshl_add_u32 v7, v6, 4, v4
    ds_read_b128 v[40:43], v7 offset:64
    s_lshl_b32 s10, s14, 2
    v_add_u32 v7, s10, v7
    ds_read_b32 v44, v7 offset:64
    v_bfe_u32 v6, v1, 2, 1
    v_lshl_add_u32 v23, v6, 4, v4
    ds_read_b128 v[48:51], v23 offset:64
    s_waitcnt lgkmcnt(0)
    v_max3_f32 v40, v40, v41, v42
    v_max3_f32 v120, v48, v49, v50
    v_max_f32 v40, v40, v43
    v_max_f32 v120, v120, v51
    v_mul_f32 v40, s77, v40
    v_mul_f32 v44, s77, v44
    v_mul_f32 v120, s77, v120
    v_add_u32 v40, 0x200, v40
    v_add_u32 v44, 0x200, v44
    v_and_b32 v40, v5, v40
    v_and_b32 v44, v5, v44
    v_sub_f32 v44, v44, v40
    v_exp_f32 v117, v44
    v_add_u32 v120, 0x200, v120
    v_and_or_b32 v120, v120, v5, s79
    v_mul_f32 v118, v118, v117
    v_mov_b32 v122, v120
    s_mov_b32 exec_lo, 1
    s_mov_b32 exec_hi, 0x100
    ds_write_b32 v21, v118 offset:96
    s_mov_b64 exec, -1
    v_and_b32 v108, v8, v85
    v_and_b32 v109, v9, v85
    v_and_b32 v110, v10, v85
    v_and_b32 v111, v11, v85
    v_mfma_f32_16x16x32_bf16 v[112:115], v[104:107], v[176:179], v[112:115]
    v_and_b32 v104, v8, v86
    v_and_b32 v105, v9, v86
    v_and_b32 v106, v10, v86
    v_and_b32 v107, v11, v86
    v_mfma_f32_16x16x32_bf16 v[112:115], v[108:111], v[180:183], v[112:115]
    s_waitcnt vmcnt(4)
    buffer_load_dwordx4 v[240:243], v20, s[48:51], s87 offen offset:0 nt
    v_and_b32 v108, v8, v87
    v_and_b32 v109, v9, v87
    v_and_b32 v110, v10, v87
    v_and_b32 v111, v11, v87
    v_mfma_f32_16x16x32_bf16 v[112:115], v[104:107], v[184:187], v[112:115]
    v_and_b32 v104, v8, v88
    v_and_b32 v105, v9, v88
    v_and_b32 v106, v10, v88
    v_and_b32 v107, v11, v88
    v_mfma_f32_16x16x32_bf16 v[112:115], v[108:111], v[188:191], v[112:115]
    s_waitcnt vmcnt(4)
    buffer_load_dwordx4 v[244:247], v20, s[48:51], s87 offen offset:1024 nt
    v_and_b32 v108, v8, v89
    v_and_b32 v109, v9, v89
    v_and_b32 v110, v10, v89
    v_and_b32 v111, v11, v89
    v_mfma_f32_16x16x32_bf16 v[112:115], v[104:107], v[192:195], v[112:115]
    v_and_b32 v104, v8, v90
    v_and_b32 v105, v9, v90
    v_and_b32 v106, v10, v90
    v_and_b32 v107, v11, v90
    v_mfma_f32_16x16x32_bf16 v[112:115], v[108:111], v[196:199], v[112:115]
    s_waitcnt vmcnt(4)
    buffer_load_dwordx4 v[248:251], v20, s[48:51], s87 offen offset:2048 nt
    v_and_b32 v108, v8, v91
    v_and_b32 v109, v9, v91
    v_and_b32 v110, v10, v91
    v_and_b32 v111, v11, v91
    v_mfma_f32_16x16x32_bf16 v[112:115], v[104:107], v[200:203], v[112:115]
    v_and_b32 v104, v8, v92
    v_and_b32 v105, v9, v92
    v_and_b32 v106, v10, v92
    v_and_b32 v107, v11, v92
    v_mfma_f32_16x16x32_bf16 v[112:115], v[108:111], v[204:207], v[112:115]
    s_waitcnt vmcnt(4)
    buffer_load_dwordx4 v[252:255], v20, s[48:51], s87 offen offset:3072 nt
    s_mov_b64 exec, 1
    v_mov_b32 v6, 1
    ds_add_u32 v4, v6 offset:12
    s_mov_b64 exec, -1
    v_and_b32 v108, v8, v93
    v_and_b32 v109, v9, v93
    v_and_b32 v110, v10, v93
    v_and_b32 v111, v11, v93
    v_mfma_f32_16x16x32_bf16 v[112:115], v[104:107], v[208:211], v[112:115]
    v_and_b32 v104, v8, v94
    v_and_b32 v105, v9, v94
    v_and_b32 v106, v10, v94
    v_and_b32 v107, v11, v94
    v_mfma_f32_16x16x32_bf16 v[112:115], v[108:111], v[212:215], v[112:115]
    v_and_b32 v108, v8, v95
    v_and_b32 v109, v9, v95
    v_and_b32 v110, v10, v95
    v_and_b32 v111, v11, v95
    v_mfma_f32_16x16x32_bf16 v[112:115], v[104:107], v[216:219], v[112:115]
    v_and_b32 v104, v8, v96
    v_and_b32 v105, v9, v96
    v_and_b32 v106, v10, v96
    v_and_b32 v107, v11, v96
    v_mfma_f32_16x16x32_bf16 v[112:115], v[108:111], v[220:223], v[112:115]
    v_and_b32 v108, v8, v97
    v_and_b32 v109, v9, v97
    v_and_b32 v110, v10, v97
    v_and_b32 v111, v11, v97
    v_mfma_f32_16x16x32_bf16 v[112:115], v[104:107], v[224:227], v[112:115]
    v_and_b32 v104, v8, v98
    v_and_b32 v105, v9, v98
    v_and_b32 v106, v10, v98
    v_and_b32 v107, v11, v98
    v_mfma_f32_16x16x32_bf16 v[112:115], v[108:111], v[228:231], v[112:115]
    v_and_b32 v108, v8, v99
    v_and_b32 v109, v9, v99
    v_and_b32 v110, v10, v99
    v_and_b32 v111, v11, v99
    v_mfma_f32_16x16x32_bf16 v[112:115], v[104:107], v[232:235], v[112:115]
    s_waitcnt vmcnt(4)
    v_and_b32 v104, v8, v100
    v_and_b32 v105, v9, v100
    v_and_b32 v106, v10, v100
    v_and_b32 v107, v11, v100
    v_mfma_f32_16x16x32_bf16 v[112:115], v[108:111], v[236:239], v[112:115]
    s_waitcnt vmcnt(3)
    v_and_b32 v108, v8, v101
    v_and_b32 v109, v9, v101
    v_and_b32 v110, v10, v101
    v_and_b32 v111, v11, v101
    v_mfma_f32_16x16x32_bf16 v[112:115], v[104:107], v[240:243], v[112:115]
    s_waitcnt vmcnt(2)
    v_and_b32 v104, v8, v102
    v_and_b32 v105, v9, v102
    v_and_b32 v106, v10, v102
    v_and_b32 v107, v11, v102
    v_mfma_f32_16x16x32_bf16 v[112:115], v[108:111], v[244:247], v[112:115]
    s_waitcnt vmcnt(1)
    v_and_b32 v108, v8, v103
    v_and_b32 v109, v9, v103
    v_and_b32 v110, v10, v103
    v_and_b32 v111, v11, v103
    v_mfma_f32_16x16x32_bf16 v[112:115], v[104:107], v[248:251], v[112:115]
    s_waitcnt vmcnt(0)
    s_nop 1
    v_mfma_f32_16x16x32_bf16 v[112:115], v[108:111], v[252:255], v[112:115]
    s_nop 7
    v_mul_f32 v112, v112, v117
    v_mul_f32 v113, v113, v117
    v_mul_f32 v114, v114, v117
    v_mul_f32 v115, v115, v117
    ds_write_b128 v126, v[112:115]
    s_waitcnt lgkmcnt(0)
    s_barrier
    s_cmp_lg_u32 s14, 1
    s_cbranch_scc1 L_send
    s_setprio 3
    ds_read_b128 v[24:27], v127 offset:0
    ds_read_b128 v[28:31], v127 offset:1024
    ds_read_b128 v[32:35], v127 offset:2048
    ds_read_b128 v[36:39], v127 offset:3072
    ds_read_b128 v[40:43], v23 offset:96
    ds_read_b32 v44, v4 offset:20
    s_waitcnt lgkmcnt(2)
    v_add_f32 v24, v24, v28
    v_add_f32 v32, v32, v36
    v_add_f32 v25, v25, v29
    v_add_f32 v33, v33, v37
    v_add_f32 v26, v26, v30
    v_add_f32 v34, v34, v38
    v_add_f32 v27, v27, v31
    v_add_f32 v35, v35, v39
    v_add_f32 v24, v24, v32
    v_add_f32 v25, v25, v33
    v_add_f32 v26, v26, v34
    v_add_f32 v27, v27, v35
    v_add_u32 v24, 0x200, v24
    v_add_u32 v25, 0x200, v25
    v_add_u32 v26, 0x200, v26
    v_add_u32 v27, 0x200, v27
    v_and_or_b32 v24, v24, v5, s79
    v_and_or_b32 v25, v25, v5, s79
    v_and_or_b32 v26, v26, v5, s79
    v_and_or_b32 v27, v27, v5, s79
    buffer_store_dwordx4 v[24:27], v124, s[64:67], s18 offen
    s_waitcnt lgkmcnt(0)
    v_add_f32 v40, v40, v41
    v_add_f32 v42, v42, v43
    v_readfirstlane_b32 s20, v44
    v_add_f32 v121, v40, v42
    v_add_u32 v121, 0x200, v121
    v_and_or_b32 v121, v121, v5, s79
    v_mov_b32 v123, v121
    s_mov_b64 exec, 0x11
    buffer_store_dwordx4 v[120:123], v125, s[64:67], s19 offen
    s_mov_b64 exec, 1
    v_mov_b32 v6, 1
    ds_write_b32 v4, v6 offset:16
    s_mov_b64 exec, -1
    s_cmp_eq_u32 s20, 1
    s_cbranch_scc1 L_send
    s_add_u32 s18, s18, 2359296
    s_add_u32 s19, s19, 2359296
    buffer_store_dwordx4 v[24:27], v124, s[64:67], s18 offen sc1
    s_mov_b64 exec, 0x11
    buffer_store_dwordx4 v[120:123], v125, s[64:67], s19 offen sc1
L_send:
    s_endpgm
L_exit:
    s_endpgm
.section .rodata,"a"
.p2align 6
.amdhsa_kernel concat_heads__sliding_block_cached__sliding_block_cached__decode_kernel
  .amdhsa_next_free_vgpr 256
  .amdhsa_next_free_sgpr 102
  .amdhsa_accum_offset 256
  .amdhsa_group_segment_fixed_size 0
  .amdhsa_kernarg_size 104
  .amdhsa_user_sgpr_count 2
  .amdhsa_user_sgpr_kernarg_segment_ptr 1
  .amdhsa_system_sgpr_workgroup_id_x 1
.end_amdhsa_kernel
```
